```python
import torch

def _softmax(x, axis=-1):
    return torch.softmax(x, dim=axis)
def _gelu(x):
    return torch.nn.functional.gelu(x, approximate="tanh")
def _silu(x):
    return torch.nn.functional.silu(x)
def _sigmoid(x):
    return torch.sigmoid(x)
def _layernorm(x, axis=-1, eps=1e-5):
    m = x.mean(dim=axis, keepdim=True)
    v = x.var(dim=axis, keepdim=True, unbiased=False)
    return (x - m) / torch.sqrt(v + eps)
def _scatter_add(tgt, idx, src, axis=0):
    return tgt.clone().index_add_(axis, idx, src)
def _segment_sum(src, seg, n):
    out = torch.zeros((n,) + src.shape[1:], dtype=src.dtype)
    return out.index_add_(0, seg, src)
def _pad(x, pw):
    flat = tuple(v for pair in reversed(pw) for v in pair)
    return torch.nn.functional.pad(x, flat)

kernel_name = 'parallel_sum__linear_attn_block__dense_activation_relu__prompt'

def setup_inputs():

    _w = (lambda a: (lambda t: t.to(torch.bfloat16) if t.is_floating_point() else t)(torch.as_tensor(a)))
    def _A_setup():
        B, S, D = 1, 2048, 640
        return {
            "x": _w((lambda *s: torch.randn(*s, dtype=torch.bfloat16) * 0.05)(B, S, D)),
            "wqkv": _w((lambda *s: torch.randn(*s, dtype=torch.bfloat16) * 0.2)(D, 3 * D)),
            "wo": _w((lambda *s: torch.randn(*s, dtype=torch.bfloat16) * 0.2)(D, D)),
        }
    _A_in = _A_setup()

    def _B_setup():
        B, S, D, Dff = 1, 2048, 640, 1728
        return {
            "x": _w((lambda *s: torch.randn(*s, dtype=torch.bfloat16) * 0.05)(B, S, D)),
            "w1": _w((lambda *s: torch.randn(*s, dtype=torch.bfloat16) * 0.05)(D, Dff)),
            "w2": _w((lambda *s: torch.randn(*s, dtype=torch.bfloat16) * 0.05)(Dff, D)),
        }
    _B_in = _B_setup()

    return {
        "A_x": _A_in["x"],
        "A_wqkv": _A_in["wqkv"],
        "A_wo": _A_in["wo"],
        "B_x": _B_in["x"],
        "B_w1": _B_in["w1"],
        "B_w2": _B_in["w2"],
    }

def reference(A_x, A_wqkv, A_wo, B_x, B_w1, B_w2):
    def _A_ref(x, wqkv, wo):
        B, S, D = x.shape
        H = 32; Dh = D // H
        qkv = (lambda x, *d: x.permute(*d))((x @ wqkv).reshape(B, S, 3, H, Dh), 2, 0, 3, 1, 4)
        q, k, v = qkv[0], qkv[1], qkv[2]
        phi = lambda t: torch.where(t > 0, t + 1, torch.exp(t)) + 1e-6
        pq, pk = phi(q), phi(k)
        kv = torch.einsum("bhsd,bhse->bhde", pk, v)
        z = torch.einsum("bhsd->bhd", pk)
        num = torch.einsum("bhqd,bhde->bhqe", pq, kv)
        den = torch.einsum("bhqd,bhd->bhq", pq, z)[..., None] + 1e-6
        o = num / den
        return (lambda x, *d: x.permute(*d))(o, 0, 2, 1, 3).reshape(B, S, D) @ wo

    def _B_ref(x, w1, w2):
        h = torch.einsum("bsd,df->bsf", x, w1)
        zero = torch.zeros_like(h)
        h = torch.maximum(h, zero)
        return torch.einsum("bsf,fd->bsd", h, w2)

    x = A_x
    xn = _layernorm(x, axis=-1)
    return x + _A_ref(xn, A_wqkv, A_wo) + _B_ref(xn, B_w1, B_w2)
```

```asm
; @launch grid=(256,1,1) block=(512,1,1) lds=112704
.amdgcn_target "amdgcn-amd-amdhsa--gfx950"
.text
.globl parallel_sum__linear_attn_block__dense_activation_relu__prompt_kernel
.p2align 8
.type parallel_sum__linear_attn_block__dense_activation_relu__prompt_kernel,@function
parallel_sum__linear_attn_block__dense_activation_relu__prompt_kernel:
  s_cmp_ge_u32 s2, 256
  s_cbranch_scc1 KM_END
  s_load_dwordx4 s[4:7], s[0:1], 0
  s_load_dwordx2 s[14:15], s[0:1], 16
  s_load_dwordx2 s[8:9], s[0:1], 32
  s_load_dwordx2 s[16:17], s[0:1], 40
  s_load_dwordx2 s[96:97], s[0:1], 48
  s_load_dwordx2 s[12:13], s[0:1], 56
  s_load_dwordx2 s[10:11], s[0:1], 64
  v_and_b32 v1, 63, v0
  v_lshrrev_b32 v2, 6, v0
  s_and_b32 s64, s2, 1
  v_readfirstlane_b32 s44, v2
  s_lshl_b32 s64, s64, 3
  s_bfe_u32 s62, s2, 0x30003
  s_or_b32 s45, s64, s62
  s_bfe_u32 s64, s2, 0x20001
  s_lshr_b32 s65, s2, 6
  s_and_b32 s66, s65, 1
  s_lshl1_add_u32 s46, s64, s66
  s_lshr_b32 s66, s65, 1
  s_lshl3_add_u32 s18, s66, s46
  s_lshr_b32 s63, s2, 3
  s_cmp_eq_u32 s44, 7
  s_cbranch_scc0 KM_NOPF
  s_getpc_b64 s[70:71]
KM_PC:
  s_sub_u32 s70, s70, KM_PC-parallel_sum__linear_attn_block__dense_activation_relu__prompt_kernel
  s_subb_u32 s71, s71, 0
  s_mul_hi_u32 s72, s63, 0x33333334
  s_mul_i32 s72, s72, 5
  s_sub_u32 s72, s63, s72
  s_lshl_b32 s72, s72, 13
  v_lshlrev_b32 v8, 7, v1
  v_add_u32 v8, s72, v8
  v_min_u32 v8, KM_CODE_END-parallel_sum__linear_attn_block__dense_activation_relu__prompt_kernel-4, v8
  v_mov_b32 v9, s71
  v_add_co_u32 v8, vcc, s70, v8
  s_nop 1
  v_addc_co_u32 v9, vcc, 0, v9, vcc
  global_load_dword v255, v[8:9], off
KM_NOPF:
  s_add_u32 s75, s45, s18
  s_mul_i32 s74, s75, 205
  s_lshr_b32 s74, s74, 11
  s_mul_i32 s74, s74, 10
  s_sub_u32 s75, s75, s74
  s_cmp_ge_u32 s44, 4
  s_cbranch_scc1 KM_SERVICE
  v_lshrrev_b32 v20, 3, v1
  v_and_b32 v21, 7, v1
  v_lshrrev_b32 v22, 4, v1
  s_lshl_b32 s47, s45, 7
  s_lshl_b32 s48, s44, 5
  s_add_u32 s47, s47, s48
  v_add_u32 v24, s47, v20
  v_mul_u32_u24 v24, 1280, v24
  v_xor_b32 v23, v22, v21
  v_lshl_add_u32 v2, v23, 4, v24
  v_xor_b32 v23, 64, v2
  v_add_u32 v3, 10240, v23
  v_add_u32 v4, 20480, v2
  v_add_u32 v5, 20480, v3
  s_lshl_b32 s55, s44, 12
  s_add_u32 s55, s55, 65536
  s_lshl_b32 s50, s75, 7
  s_waitcnt lgkmcnt(0)
  s_mov_b32 s20, s4
  s_mov_b32 s21, s5
  s_mov_b32 s22, 2621440
  s_mov_b32 s23, 0x20000
  s_add_u32 m0, s55, 0
  s_nop 0
  buffer_load_dwordx4 v2, s[20:23], s50 offen lds
  s_add_u32 m0, s55, 1024
  s_nop 0
  buffer_load_dwordx4 v3, s[20:23], s50 offen lds
  s_add_u32 m0, s55, 2048
  s_nop 0
  buffer_load_dwordx4 v4, s[20:23], s50 offen lds
  s_add_u32 m0, s55, 3072
  s_nop 0
  buffer_load_dwordx4 v5, s[20:23], s50 offen lds
  s_add_u32 s50, s50, 128
  s_cmp_eq_u32 s50, 1280
  s_cselect_b32 s50, 0, s50
  s_cmp_ge_u32 s65, 2
  s_cbranch_scc1 K1_HQ
K1_KV:
  s_cmp_lt_u32 s44, 3
  s_cbranch_scc0 K1_KV_HD
  s_mov_b32 s24, s6
  s_mov_b32 s25, s7
  s_mov_b32 s26, 2457600
  s_mov_b32 s27, 0x20000
  s_mov_b32 s52, 122880
  s_mul_i32 s67, s46, 160
  s_add_u32 s67, s67, 1280
  s_lshl_b32 s64, s44, 1
  s_lshl_b32 s70, s64, 6
  v_add_u32 v22, s70, v1
  v_mul_u32_u24 v23, 6554, v22
  v_lshrrev_b32 v23, 16, v23
  v_mul_u32_u24 v24, 10, v23
  v_sub_u32 v22, v22, v24
  v_and_b32 v24, 0x13, v23
  v_bfe_u32 v25, v23, 2, 1
  v_lshl_or_b32 v24, v25, 3, v24
  v_bfe_u32 v25, v23, 3, 1
  v_lshl_or_b32 v24, v25, 2, v24
  v_mul_u32_u24 v24, 3840, v24
  v_lshl_add_u32 v24, v22, 4, v24
  s_lshl_b32 s53, s64, 10
  s_add_u32 s54, s53, 5136
  v_add_u32 v248, s67, v24
  v_add_u32 v249, 1280, v248
  s_lshl_b32 s64, s44, 1
  s_add_u32 s64, s64, 1
  s_lshl_b32 s70, s64, 6
  v_add_u32 v22, s70, v1
  v_mul_u32_u24 v23, 6554, v22
  v_lshrrev_b32 v23, 16, v23
  v_mul_u32_u24 v24, 10, v23
  v_sub_u32 v22, v22, v24
  v_and_b32 v24, 0x13, v23
  v_bfe_u32 v25, v23, 2, 1
  v_lshl_or_b32 v24, v25, 3, v24
  v_bfe_u32 v25, v23, 3, 1
  v_lshl_or_b32 v24, v25, 2, v24
  v_mul_u32_u24 v24, 3840, v24
  v_lshl_add_u32 v24, v22, 4, v24
  s_lshl_b32 s36, s64, 10
  s_add_u32 s37, s36, 5136
  s_cmp_ge_u32 s64, 5
  s_cselect_b32 s67, 1073741824, s67
  s_cselect_b32 s36, 15360, s36
  s_cselect_b32 s37, 15360, s37
  v_add_u32 v250, s67, v24
  v_add_u32 v251, 1280, v250
  s_branch K1_KV_D1
K1_KV_HD:
  s_mov_b32 s24, s8
  s_mov_b32 s25, s9
  s_mov_b32 s26, 2211840
  s_mov_b32 s27, 0x20000
  s_mov_b32 s52, 110592
  s_mov_b32 s65, 3456
  s_lshl_b32 s66, s46, 7
  s_mov_b32 s53, 10496
  s_mov_b32 s54, 11520
  s_mov_b32 s36, 12544
  s_mov_b32 s37, 13568
  v_bfe_u32 v22, v1, 4, 1
  v_lshlrev_b32 v22, 1, v22
  v_xor_b32 v22, v22, v21
  v_mul_lo_u32 v24, v20, s65
  v_lshl_add_u32 v24, v22, 4, v24
  v_add_u32 v248, s66, v24
  s_lshl_b32 s47, s65, 3
  s_lshl_b32 s48, s65, 4
  v_xor_b32 v24, 64, v248
  v_add_u32 v249, s47, v24
  v_add_u32 v250, s48, v248
  v_add_u32 v251, s48, v249
K1_KV_D1:
  s_mul_i32 s51, s75, s52
  s_lshl_b32 s51, s51, 1
  s_mul_i32 s56, s52, 20
  s_add_u32 m0, s53, 0
  s_nop 0
  buffer_load_dwordx4 v248, s[24:27], s51 offen lds
  s_add_u32 m0, s54, 0
  s_nop 0
  buffer_load_dwordx4 v249, s[24:27], s51 offen lds
  s_add_u32 m0, s36, 0
  s_nop 0
  buffer_load_dwordx4 v250, s[24:27], s51 offen lds
  s_add_u32 m0, s37, 0
  s_nop 0
  buffer_load_dwordx4 v251, s[24:27], s51 offen lds
  s_add_u32 s51, s51, s52
  s_add_u32 m0, s53, 16384
  s_nop 0
  buffer_load_dwordx4 v248, s[24:27], s51 offen lds
  s_add_u32 m0, s54, 16384
  s_nop 0
  buffer_load_dwordx4 v249, s[24:27], s51 offen lds
  s_add_u32 m0, s36, 16384
  s_nop 0
  buffer_load_dwordx4 v250, s[24:27], s51 offen lds
  s_add_u32 m0, s37, 16384
  s_nop 0
  buffer_load_dwordx4 v251, s[24:27], s51 offen lds
  s_add_u32 s51, s51, s52
  s_cmp_eq_u32 s51, s56
  s_cselect_b32 s51, 0, s51
  s_add_u32 m0, s55, 16384
  s_nop 0
  buffer_load_dwordx4 v2, s[20:23], s50 offen lds
  s_add_u32 m0, s55, 17408
  s_nop 0
  buffer_load_dwordx4 v3, s[20:23], s50 offen lds
  s_add_u32 m0, s55, 18432
  s_nop 0
  buffer_load_dwordx4 v4, s[20:23], s50 offen lds
  s_add_u32 m0, s55, 19456
  s_nop 0
  buffer_load_dwordx4 v5, s[20:23], s50 offen lds
  s_add_u32 s50, s50, 128
  s_cmp_eq_u32 s50, 1280
  s_cselect_b32 s50, 0, s50
  s_mov_b32 s60, 1000
  s_branch K1_KV_NODMA
K1_HQ:
  s_mov_b32 s64, 0x81800908
  s_cmp_eq_u32 s46, 1
  s_cselect_b32 s64, 0x83820b0a, s64
  s_cmp_eq_u32 s46, 2
  s_cselect_b32 s64, 0xe840d0c, s64
  s_cmp_eq_u32 s46, 3
  s_cselect_b32 s64, 0x1185100f, s64
  s_cmp_eq_u32 s46, 4
  s_cselect_b32 s64, 0x14861312, s64
  s_cmp_eq_u32 s46, 5
  s_cselect_b32 s64, 0x56871615, s64
  s_cmp_eq_u32 s46, 6
  s_cselect_b32 s64, 0x58881817, s64
  s_cmp_eq_u32 s46, 7
  s_cselect_b32 s64, 0x5a891a19, s64
  s_lshl_b32 s65, s44, 3
  s_lshr_b32 s64, s64, s65
  s_bitcmp1_b32 s64, 7
  s_cselect_b32 s24, s6, s8
  s_cselect_b32 s25, s7, s9
  s_mov_b32 s26, 2457600
  s_cselect_b32 s26, s26, 2211840
  s_mov_b32 s27, 0x20000
  s_mov_b32 s65, 3840
  s_cselect_b32 s65, s65, 3456
  s_lshl_b32 s52, s65, 5
  s_and_b32 s66, s64, 63
  s_lshl_b32 s66, s66, 7
  v_bfe_u32 v22, v1, 4, 1
  v_lshlrev_b32 v22, 1, v22
  v_xor_b32 v22, v22, v21
  v_mul_lo_u32 v24, v20, s65
  v_lshl_add_u32 v24, v22, 4, v24
  v_add_u32 v248, s66, v24
  s_lshl_b32 s47, s65, 3
  s_lshl_b32 s48, s65, 4
  v_xor_b32 v24, 64, v248
  v_add_u32 v249, s47, v24
  v_add_u32 v250, s48, v248
  v_add_u32 v251, s48, v249
  s_lshl_b32 s66, s44, 12
  s_add_u32 s53, s66, 0
  s_add_u32 s54, s66, 1024
  s_add_u32 s36, s66, 2048
  s_add_u32 s37, s66, 3072
  s_mul_i32 s51, s75, s52
  s_lshl_b32 s51, s51, 1
  s_mul_i32 s56, s52, 20
  s_add_u32 m0, s53, 0
  s_nop 0
  buffer_load_dwordx4 v248, s[24:27], s51 offen lds
  s_add_u32 m0, s54, 0
  s_nop 0
  buffer_load_dwordx4 v249, s[24:27], s51 offen lds
  s_add_u32 m0, s36, 0
  s_nop 0
  buffer_load_dwordx4 v250, s[24:27], s51 offen lds
  s_add_u32 m0, s37, 0
  s_nop 0
  buffer_load_dwordx4 v251, s[24:27], s51 offen lds
  s_add_u32 s51, s51, s52
  s_add_u32 m0, s53, 16384
  s_nop 0
  buffer_load_dwordx4 v248, s[24:27], s51 offen lds
  s_add_u32 m0, s54, 16384
  s_nop 0
  buffer_load_dwordx4 v249, s[24:27], s51 offen lds
  s_add_u32 m0, s36, 16384
  s_nop 0
  buffer_load_dwordx4 v250, s[24:27], s51 offen lds
  s_add_u32 m0, s37, 16384
  s_nop 0
  buffer_load_dwordx4 v251, s[24:27], s51 offen lds
  s_add_u32 s51, s51, s52
  s_cmp_eq_u32 s51, s56
  s_cselect_b32 s51, 0, s51
  s_add_u32 m0, s55, 16384
  s_nop 0
  buffer_load_dwordx4 v2, s[20:23], s50 offen lds
  s_add_u32 m0, s55, 17408
  s_nop 0
  buffer_load_dwordx4 v3, s[20:23], s50 offen lds
  s_add_u32 m0, s55, 18432
  s_nop 0
  buffer_load_dwordx4 v4, s[20:23], s50 offen lds
  s_add_u32 m0, s55, 19456
  s_nop 0
  buffer_load_dwordx4 v5, s[20:23], s50 offen lds
  s_add_u32 s50, s50, 128
  s_cmp_eq_u32 s50, 1280
  s_cselect_b32 s50, 0, s50
  s_mov_b32 s60, 1000
  s_branch K1_HQ_NODMA
KM_SERVICE:
  v_mov_b32 v2, 0
  v_mov_b32 v3, 0
  v_mov_b32 v4, 0
  v_mov_b32 v5, 0
  v_mov_b32 v6, 112640
  ds_write_b64 v6, v[4:5] offset:0
  ds_write_b64 v6, v[4:5] offset:8
  ds_write_b64 v6, v[4:5] offset:16
  ds_write_b64 v6, v[4:5] offset:24
  ds_write_b64 v6, v[4:5] offset:32
  s_waitcnt lgkmcnt(0)
  s_mov_b32 s20, s4
  s_mov_b32 s21, s5
  s_mov_b32 s22, 2621440
  s_mov_b32 s23, 0x20000
  s_mov_b32 s50, 0
  s_mov_b32 s55, 0
  v_mov_b32 v248, 0
  v_mov_b32 v249, 0
  v_mov_b32 v250, 0
  v_mov_b32 v251, 0
  s_mov_b32 s24, s4
  s_mov_b32 s25, s5
  s_mov_b32 s26, 2621440
  s_mov_b32 s27, 0x20000
  s_sub_u32 s64, s44, 4
  s_mul_i32 s60, s2, 3
  s_add_u32 s60, s60, s64
  s_cmp_lt_u32 s64, 3
  s_cselect_b32 s60, s60, 1000
  s_cmp_lt_u32 s60, 740
  s_cbranch_scc0 KM_NOJOB
  s_mov_b32 s73, s65
  s_mul_hi_u32 s98, s60, 0x1999999a
  s_mul_i32 s63, s98, 10
  s_sub_u32 s99, s60, s63
  s_cmp_lt_u32 s98, 54
  s_cselect_b32 s36, s16, s14
  s_cselect_b32 s37, s17, s15
  s_mov_b32 s38, 2211840
  s_cselect_b32 s38, s38, 819200
  s_mov_b32 s39, 0x20000
  s_cselect_b32 s64, 0, 54
  s_sub_u32 s100, s98, s64
  s_mul_i32 s65, s100, 40960
  s_lshl_b32 s66, s99, 7
  s_add_u32 s65, s65, s66
  v_lshrrev_b32 v10, 3, v1
  v_mul_u32_u24 v10, 1280, v10
  v_and_b32 v11, 7, v1
  v_lshl_add_u32 v10, v11, 4, v10
  s_lshl_b32 s66, s44, 12
  s_add_u32 m0, s66, 81920
  s_nop 0
  buffer_load_dwordx4 v10, s[36:39], s65 offen lds
  s_add_u32 s65, s65, 10240
  s_add_u32 m0, s66, 82944
  s_nop 0
  buffer_load_dwordx4 v10, s[36:39], s65 offen lds
  s_add_u32 s65, s65, 10240
  s_add_u32 m0, s66, 83968
  s_nop 0
  buffer_load_dwordx4 v10, s[36:39], s65 offen lds
  s_add_u32 s65, s65, 10240
  s_add_u32 m0, s66, 84992
  s_nop 0
  buffer_load_dwordx4 v10, s[36:39], s65 offen lds
  s_mov_b32 s65, s73
KM_NOJOB:
  s_cmp_ge_u32 s65, 2
  s_cbranch_scc1 K1_HQ_NODMA
  s_branch K1_KV_NODMA
K1_KV_NODMA:
  s_and_b32 s62, s44, 1
  s_lshr_b32 s63, s44, 1
  s_mov_b32 s28, s10
  s_mov_b32 s29, s11
  s_mov_b32 s30, 17956864
  s_mov_b32 s31, 0x20000
  s_mov_b32 s32, s12
  s_mov_b32 s33, s13
  s_mov_b32 s34, 256
  s_mov_b32 s35, 0x20000
  v_lshrrev_b32 v56, 4, v1
  v_bfe_u32 v57, v1, 2, 2
  v_and_b32 v58, 3, v1
  v_lshrrev_b32 v59, 1, v56
  v_lshlrev_b32 v59, 4, v59
  v_and_b32 v60, 1, v56
  v_lshl_add_u32 v59, v60, 2, v59
  v_add_u32 v59, v59, v57
  v_mul_u32_u24 v59, 160, v59
  s_mul_i32 s64, s62, 80
  v_add_u32 v59, s64, v59
  v_lshl_add_u32 v16, v58, 3, v59
  v_add_u32 v18, 5152, v16
  v_add_u32 v60, 64, v16
  v_add_u32 v61, 5120, v16
  v_cmp_gt_u32 vcc, 2, v58
  s_nop 1
  v_cndmask_b32 v17, v61, v60, vcc
  s_lshl_b32 s64, s62, 1
  s_mov_b32 s66, 10496
  v_lshrrev_b32 v56, 4, v1
  v_bfe_u32 v57, v1, 2, 2
  v_bfe_u32 v58, v1, 1, 1
  v_lshrrev_b32 v59, 1, v57
  v_and_b32 v60, 1, v56
  v_lshl_or_b32 v59, v60, 1, v59
  v_lshlrev_b32 v59, 1, v59
  s_xor_b32 s48, s64, 0
  s_lshl_b32 s48, s48, 1
  v_or_b32 v60, s48, v58
  v_xor_b32 v60, v60, v59
  v_lshl_add_u32 v61, v56, 3, v57
  v_lshlrev_b32 v61, 7, v61
  v_lshl_add_u32 v61, v60, 4, v61
  v_and_b32 v60, 1, v1
  v_lshl_add_u32 v61, v60, 3, v61
  v_add_u32 v61, s66, v61
  v_mov_b32 v19, v61
  v_lshrrev_b32 v56, 4, v1
  v_bfe_u32 v57, v1, 2, 2
  v_bfe_u32 v58, v1, 1, 1
  v_lshrrev_b32 v59, 1, v57
  v_and_b32 v60, 1, v56
  v_lshl_or_b32 v59, v60, 1, v59
  v_lshlrev_b32 v59, 1, v59
  s_xor_b32 s48, s64, 1
  s_lshl_b32 s48, s48, 1
  v_or_b32 v60, s48, v58
  v_xor_b32 v60, v60, v59
  v_lshl_add_u32 v61, v56, 3, v57
  v_lshlrev_b32 v61, 7, v61
  v_lshl_add_u32 v61, v60, 4, v61
  v_and_b32 v60, 1, v1
  v_lshl_add_u32 v61, v60, 3, v61
  v_add_u32 v61, s66, v61
  v_mov_b32 v20, v61
  v_and_b32 v56, 15, v1
  v_lshrrev_b32 v57, 4, v1
  v_lshrrev_b32 v58, 1, v56
  s_xor_b32 s64, s62, 0
  s_lshl_b32 s64, s64, 4
  s_lshl_b32 s65, s63, 5
  s_add_u32 s64, s64, s65
  v_add_u32 v60, s64, v56
  v_lshlrev_b32 v60, 7, v60
  v_or_b32 v59, 0, v57
  v_xor_b32 v59, v59, v58
  v_lshl_add_u32 v59, v59, 4, v60
  v_add_u32 v21, 65536, v59
  v_or_b32 v59, 4, v57
  v_xor_b32 v59, v59, v58
  v_lshl_add_u32 v59, v59, 4, v60
  v_add_u32 v23, 65536, v59
  s_xor_b32 s64, s62, 1
  s_lshl_b32 s64, s64, 4
  s_lshl_b32 s65, s63, 5
  s_add_u32 s64, s64, s65
  v_add_u32 v60, s64, v56
  v_lshlrev_b32 v60, 7, v60
  v_or_b32 v59, 0, v57
  v_xor_b32 v59, v59, v58
  v_lshl_add_u32 v59, v59, 4, v60
  v_add_u32 v22, 65536, v59
  v_or_b32 v59, 4, v57
  v_xor_b32 v59, v59, v58
  v_lshl_add_u32 v59, v59, 4, v60
  v_add_u32 v24, 65536, v59
  v_mul_u32_u24 v59, 80, v56
  v_lshl_add_u32 v59, v57, 4, v59
  s_mul_i32 s64, s63, 6720
  s_mul_i32 s65, s62, 3360
  s_add_u32 s64, s64, s65
  s_add_u32 s64, s64, 32128
  v_add_u32 v25, s64, v59
  v_mov_b32 v31, 0
  s_lshl_b32 s74, s45, 7
  s_add_u32 s74, s74, 16842752
  s_lshl_b32 s75, s18, 7
  s_add_u32 s75, s75, 16844800
  v_mov_b32 v11, s74
  v_mov_b32 v8, s75
  v_and_b32 v9, 1, v1
  v_cmp_eq_u32 vcc, 1, v9
  s_nop 1
  v_cndmask_b32 v28, v11, v8, vcc
  v_mov_b32 v240, 0
  v_mov_b32 v241, 0
  v_mov_b32 v242, 0
  v_mov_b32 v243, 0
  v_mov_b32 v244, 0
  v_mov_b32 v245, 0
  v_mov_b32 v246, 0
  v_mov_b32 v247, 0
  v_mov_b32 v32, 0
  v_mov_b32 v33, 0
  v_mov_b32 v34, 0
  v_mov_b32 v35, 0
  v_mov_b32 v36, 0
  v_mov_b32 v37, 0
  v_mov_b32 v38, 0
  v_mov_b32 v39, 0
  v_mov_b32 v40, 0
  v_mov_b32 v41, 0
  v_mov_b32 v42, 0
  v_mov_b32 v43, 0
  v_mov_b32 v44, 0
  v_mov_b32 v45, 0
  v_mov_b32 v46, 0
  v_mov_b32 v47, 0
  v_mov_b32 v48, 0
  v_mov_b32 v49, 0
  v_mov_b32 v50, 0
  v_mov_b32 v51, 0
  v_mov_b32 v52, 0
  v_mov_b32 v53, 0
  v_mov_b32 v54, 0
  v_mov_b32 v55, 0
  v_mov_b32 v56, 0
  v_mov_b32 v57, 0
  v_mov_b32 v58, 0
  v_mov_b32 v59, 0
  v_mov_b32 v60, 0
  v_mov_b32 v61, 0
  v_mov_b32 v62, 0
  v_mov_b32 v63, 0
  v_mov_b32 v64, 0
  v_mov_b32 v65, 0
  v_mov_b32 v66, 0
  v_mov_b32 v67, 0
  v_mov_b32 v68, 0
  v_mov_b32 v69, 0
  v_mov_b32 v70, 0
  v_mov_b32 v71, 0
  v_mov_b32 v72, 0
  v_mov_b32 v73, 0
  v_mov_b32 v74, 0
  v_mov_b32 v75, 0
  v_mov_b32 v76, 0
  v_mov_b32 v77, 0
  v_mov_b32 v78, 0
  v_mov_b32 v79, 0
  v_mov_b32 v80, 0
  v_mov_b32 v81, 0
  v_mov_b32 v82, 0
  v_mov_b32 v83, 0
  v_mov_b32 v84, 0
  v_mov_b32 v85, 0
  v_mov_b32 v86, 0
  v_mov_b32 v87, 0
  v_mov_b32 v200, 0
  v_mov_b32 v201, 0
  v_mov_b32 v202, 0
  v_mov_b32 v203, 0
  v_mov_b32 v204, 0
  v_mov_b32 v205, 0
  v_mov_b32 v206, 0
  v_mov_b32 v207, 0
  v_mov_b32 v208, 0
  v_mov_b32 v209, 0
  v_mov_b32 v210, 0
  v_mov_b32 v211, 0
  v_mov_b32 v212, 0
  v_mov_b32 v213, 0
  v_mov_b32 v214, 0
  v_mov_b32 v215, 0
  v_mov_b32 v216, 0
  v_mov_b32 v217, 0
  v_mov_b32 v218, 0
  v_mov_b32 v219, 0
  v_mov_b32 v220, 0
  v_mov_b32 v221, 0
  v_mov_b32 v222, 0
  v_mov_b32 v223, 0
  v_mov_b32 v224, 0
  v_mov_b32 v225, 0
  v_mov_b32 v226, 0
  v_mov_b32 v227, 0
  v_mov_b32 v12, 0x3f803f80
  v_mov_b32 v13, 0x3f803f80
  v_mov_b32 v14, 0x3f803f80
  v_mov_b32 v15, 0x3f803f80
  s_waitcnt vmcnt(8)
  s_barrier
  ds_read_b64_tr_b16 v[96:97], v16 offset:0
  ds_read_b64_tr_b16 v[98:99], v16 offset:1280
  ds_read_b64_tr_b16 v[100:101], v16 offset:32
  ds_read_b64_tr_b16 v[102:103], v16 offset:1312
  ds_read_b64_tr_b16 v[104:105], v17 offset:0
  ds_read_b64_tr_b16 v[106:107], v17 offset:1280
  ds_read_b64_tr_b16 v[108:109], v18 offset:0
  ds_read_b64_tr_b16 v[110:111], v18 offset:1280
  ds_read_b64_tr_b16 v[112:113], v18 offset:32
  ds_read_b64_tr_b16 v[114:115], v18 offset:1312
  ds_read_b64_tr_b16 v[116:117], v19 offset:0
  ds_read_b64_tr_b16 v[118:119], v19 offset:512
  ds_read_b64_tr_b16 v[120:121], v20 offset:0
  ds_read_b64_tr_b16 v[122:123], v20 offset:512
  ds_read_b128 v[152:155], v21 offset:0
  ds_read_b128 v[156:159], v22 offset:0
  ds_read_b128 v[160:163], v23 offset:0
  ds_read_b128 v[164:167], v24 offset:0
  s_cmp_ge_u32 s44, 4
  s_cbranch_scc1 K1_KV_NOP2
  s_add_u32 m0, s53, 32768
  s_nop 0
  buffer_load_dwordx4 v248, s[24:27], s51 offen lds
  s_add_u32 m0, s54, 32768
  s_nop 0
  buffer_load_dwordx4 v249, s[24:27], s51 offen lds
  s_add_u32 m0, s36, 32768
  s_nop 0
  buffer_load_dwordx4 v250, s[24:27], s51 offen lds
  s_add_u32 m0, s37, 32768
  s_nop 0
  buffer_load_dwordx4 v251, s[24:27], s51 offen lds
  s_add_u32 s51, s51, s52
  s_add_u32 m0, s53, 49152
  s_nop 0
  buffer_load_dwordx4 v248, s[24:27], s51 offen lds
  s_add_u32 m0, s54, 49152
  s_nop 0
  buffer_load_dwordx4 v249, s[24:27], s51 offen lds
  s_add_u32 m0, s36, 49152
  s_nop 0
  buffer_load_dwordx4 v250, s[24:27], s51 offen lds
  s_add_u32 m0, s37, 49152
  s_nop 0
  buffer_load_dwordx4 v251, s[24:27], s51 offen lds
  s_add_u32 s51, s51, s52
  s_cmp_eq_u32 s51, s56
  s_cselect_b32 s51, 0, s51
K1_KV_NOP2:
  s_waitcnt vmcnt(12) lgkmcnt(0)
  s_mov_b32 s47, 6
  s_mov_b32 s49, 4
  s_cmp_ge_u32 s44, 4
  s_cselect_b32 s63, 8192, 0
  s_or_b32 s49, s49, s63
  s_cmp_eq_u32 s44, 7
  s_cselect_b32 s63, 4808, 0
  s_or_b32 s49, s49, s63
  s_cmp_lt_u32 s60, 740
  s_cselect_b32 s63, 64, 0
  s_or_b32 s49, s49, s63
  s_mov_b32 s19, 0
  s_mov_b64 vcc, 0
  s_cmp_ge_u32 s44, 4
  s_cbranch_scc1 K1_KVS_LOOP
K1_KVL_LOOP:
  s_barrier
  s_cbranch_vccnz K1_KVL_HK0
K1_KVL_HK0_B:
  v_mfma_f32_16x16x32_bf16 v[32:35], v[152:155], v[96:99], v[32:35]
  s_add_u32 m0, s55, 0
  s_nop 0
  buffer_load_dwordx4 v2, s[20:23], s50 offen lds
  s_add_u32 m0, s55, 1024
  s_nop 0
  buffer_load_dwordx4 v3, s[20:23], s50 offen lds
  v_mfma_f32_16x16x32_bf16 v[36:39], v[156:159], v[96:99], v[36:39]
  s_add_u32 m0, s55, 2048
  s_nop 0
  buffer_load_dwordx4 v4, s[20:23], s50 offen lds
  s_add_u32 m0, s55, 3072
  s_nop 0
  buffer_load_dwordx4 v5, s[20:23], s50 offen lds
  s_add_u32 s50, s50, 128
  v_mfma_f32_16x16x32_bf16 v[40:43], v[152:155], v[100:103], v[40:43]
  s_cmp_eq_u32 s50, 1280
  s_cselect_b32 s50, 0, s50
  s_add_u32 m0, s53, 0
  s_nop 0
  buffer_load_dwordx4 v248, s[24:27], s51 offen lds
  v_mfma_f32_16x16x32_bf16 v[44:47], v[156:159], v[100:103], v[44:47]
  s_add_u32 m0, s54, 0
  s_nop 0
  buffer_load_dwordx4 v249, s[24:27], s51 offen lds
  s_add_u32 m0, s36, 0
  s_nop 0
  buffer_load_dwordx4 v250, s[24:27], s51 offen lds
  v_mfma_f32_16x16x32_bf16 v[48:51], v[152:155], v[104:107], v[48:51]
  s_add_u32 m0, s37, 0
  s_nop 0
  buffer_load_dwordx4 v251, s[24:27], s51 offen lds
  s_add_u32 s51, s51, s52
  ds_read_b64_tr_b16 v[124:125], v16 offset:16384
  v_mfma_f32_16x16x32_bf16 v[52:55], v[156:159], v[104:107], v[52:55]
  ds_read_b64_tr_b16 v[126:127], v16 offset:17664
  ds_read_b64_tr_b16 v[128:129], v16 offset:16416
  v_mfma_f32_16x16x32_bf16 v[56:59], v[152:155], v[108:111], v[56:59]
  ds_read_b64_tr_b16 v[130:131], v16 offset:17696
  ds_read_b64_tr_b16 v[132:133], v17 offset:16384
  v_mfma_f32_16x16x32_bf16 v[60:63], v[156:159], v[108:111], v[60:63]
  ds_read_b64_tr_b16 v[134:135], v17 offset:17664
  ds_read_b64_tr_b16 v[136:137], v18 offset:16384
  v_mfma_f32_16x16x32_bf16 v[64:67], v[152:155], v[112:115], v[64:67]
  ds_read_b64_tr_b16 v[138:139], v18 offset:17664
  ds_read_b64_tr_b16 v[140:141], v18 offset:16416
  v_mfma_f32_16x16x32_bf16 v[68:71], v[156:159], v[112:115], v[68:71]
  ds_read_b64_tr_b16 v[142:143], v18 offset:17696
  ds_read_b64_tr_b16 v[144:145], v19 offset:16384
  v_mfma_f32_16x16x32_bf16 v[72:75], v[116:119], v[152:155], v[72:75]
  ds_read_b64_tr_b16 v[146:147], v19 offset:16896
  ds_read_b64_tr_b16 v[148:149], v20 offset:16384
  v_mfma_f32_16x16x32_bf16 v[76:79], v[116:119], v[156:159], v[76:79]
  ds_read_b64_tr_b16 v[150:151], v20 offset:16896
  v_mfma_f32_16x16x32_bf16 v[80:83], v[120:123], v[152:155], v[80:83]
  s_add_u32 s19, s19, 1
  s_lshr_b32 s62, s49, s19
  v_mfma_f32_16x16x32_bf16 v[84:87], v[120:123], v[156:159], v[84:87]
  s_and_b32 vcc_lo, s62, 1
  s_bitcmp1_b32 s47, s19
  s_cbranch_scc1 K1_KVL_XT0
K1_KVL_XT0_B:
  s_waitcnt vmcnt(12) lgkmcnt(0)
  s_barrier
  s_cbranch_vccnz K1_KVL_HK1
K1_KVL_HK1_B:
  v_mfma_f32_16x16x32_bf16 v[32:35], v[160:163], v[124:127], v[32:35]
  s_add_u32 m0, s53, 16384
  s_nop 0
  buffer_load_dwordx4 v248, s[24:27], s51 offen lds
  s_add_u32 m0, s54, 16384
  s_nop 0
  buffer_load_dwordx4 v249, s[24:27], s51 offen lds
  v_mfma_f32_16x16x32_bf16 v[36:39], v[164:167], v[124:127], v[36:39]
  s_add_u32 m0, s36, 16384
  s_nop 0
  buffer_load_dwordx4 v250, s[24:27], s51 offen lds
  s_add_u32 m0, s37, 16384
  s_nop 0
  buffer_load_dwordx4 v251, s[24:27], s51 offen lds
  s_add_u32 s51, s51, s52
  v_mfma_f32_16x16x32_bf16 v[40:43], v[160:163], v[128:131], v[40:43]
  s_cmp_eq_u32 s51, s56
  s_cselect_b32 s51, 0, s51
  ds_read_b64_tr_b16 v[96:97], v16 offset:32768
  v_mfma_f32_16x16x32_bf16 v[44:47], v[164:167], v[128:131], v[44:47]
  ds_read_b64_tr_b16 v[98:99], v16 offset:34048
  ds_read_b64_tr_b16 v[100:101], v16 offset:32800
  v_mfma_f32_16x16x32_bf16 v[48:51], v[160:163], v[132:135], v[48:51]
  ds_read_b64_tr_b16 v[102:103], v16 offset:34080
  ds_read_b64_tr_b16 v[104:105], v17 offset:32768
  v_mfma_f32_16x16x32_bf16 v[52:55], v[164:167], v[132:135], v[52:55]
  ds_read_b64_tr_b16 v[106:107], v17 offset:34048
  ds_read_b64_tr_b16 v[108:109], v18 offset:32768
  v_mfma_f32_16x16x32_bf16 v[56:59], v[160:163], v[136:139], v[56:59]
  ds_read_b64_tr_b16 v[110:111], v18 offset:34048
  ds_read_b64_tr_b16 v[112:113], v18 offset:32800
  v_mfma_f32_16x16x32_bf16 v[60:63], v[164:167], v[136:139], v[60:63]
  ds_read_b64_tr_b16 v[114:115], v18 offset:34080
  ds_read_b64_tr_b16 v[116:117], v19 offset:32768
  v_mfma_f32_16x16x32_bf16 v[64:67], v[160:163], v[140:143], v[64:67]
  ds_read_b64_tr_b16 v[118:119], v19 offset:33280
  ds_read_b64_tr_b16 v[120:121], v20 offset:32768
  v_mfma_f32_16x16x32_bf16 v[68:71], v[164:167], v[140:143], v[68:71]
  ds_read_b64_tr_b16 v[122:123], v20 offset:33280
  ds_read_b128 v[168:171], v21 offset:16384
  v_mfma_f32_16x16x32_bf16 v[72:75], v[144:147], v[160:163], v[72:75]
  ds_read_b128 v[172:175], v22 offset:16384
  ds_read_b128 v[176:179], v23 offset:16384
  v_mfma_f32_16x16x32_bf16 v[76:79], v[144:147], v[164:167], v[76:79]
  ds_read_b128 v[180:183], v24 offset:16384
  v_mfma_f32_16x16x32_bf16 v[80:83], v[148:151], v[160:163], v[80:83]
  s_add_u32 s19, s19, 1
  s_lshr_b32 s62, s49, s19
  v_mfma_f32_16x16x32_bf16 v[84:87], v[148:151], v[164:167], v[84:87]
  s_and_b32 vcc_lo, s62, 1
  s_bitcmp1_b32 s47, s19
  s_cbranch_scc1 K1_KVL_XT1
K1_KVL_XT1_B:
  s_waitcnt vmcnt(12) lgkmcnt(0)
  s_barrier
  s_cbranch_vccnz K1_KVL_HK2
K1_KVL_HK2_B:
  v_mfma_f32_16x16x32_bf16 v[32:35], v[168:171], v[96:99], v[32:35]
  s_add_u32 m0, s55, 16384
  s_nop 0
  buffer_load_dwordx4 v2, s[20:23], s50 offen lds
  s_add_u32 m0, s55, 17408
  s_nop 0
  buffer_load_dwordx4 v3, s[20:23], s50 offen lds
  v_mfma_f32_16x16x32_bf16 v[36:39], v[172:175], v[96:99], v[36:39]
  s_add_u32 m0, s55, 18432
  s_nop 0
  buffer_load_dwordx4 v4, s[20:23], s50 offen lds
  s_add_u32 m0, s55, 19456
  s_nop 0
  buffer_load_dwordx4 v5, s[20:23], s50 offen lds
  s_add_u32 s50, s50, 128
  v_mfma_f32_16x16x32_bf16 v[40:43], v[168:171], v[100:103], v[40:43]
  s_cmp_eq_u32 s50, 1280
  s_cselect_b32 s50, 0, s50
  s_add_u32 m0, s53, 32768
  s_nop 0
  buffer_load_dwordx4 v248, s[24:27], s51 offen lds
  v_mfma_f32_16x16x32_bf16 v[44:47], v[172:175], v[100:103], v[44:47]
  s_add_u32 m0, s54, 32768
  s_nop 0
  buffer_load_dwordx4 v249, s[24:27], s51 offen lds
  s_add_u32 m0, s36, 32768
  s_nop 0
  buffer_load_dwordx4 v250, s[24:27], s51 offen lds
  v_mfma_f32_16x16x32_bf16 v[48:51], v[168:171], v[104:107], v[48:51]
  s_add_u32 m0, s37, 32768
  s_nop 0
  buffer_load_dwordx4 v251, s[24:27], s51 offen lds
  s_add_u32 s51, s51, s52
  ds_read_b64_tr_b16 v[124:125], v16 offset:49152
  v_mfma_f32_16x16x32_bf16 v[52:55], v[172:175], v[104:107], v[52:55]
  ds_read_b64_tr_b16 v[126:127], v16 offset:50432
  ds_read_b64_tr_b16 v[128:129], v16 offset:49184
  v_mfma_f32_16x16x32_bf16 v[56:59], v[168:171], v[108:111], v[56:59]
  ds_read_b64_tr_b16 v[130:131], v16 offset:50464
  ds_read_b64_tr_b16 v[132:133], v17 offset:49152
  v_mfma_f32_16x16x32_bf16 v[60:63], v[172:175], v[108:111], v[60:63]
  ds_read_b64_tr_b16 v[134:135], v17 offset:50432
  ds_read_b64_tr_b16 v[136:137], v18 offset:49152
  v_mfma_f32_16x16x32_bf16 v[64:67], v[168:171], v[112:115], v[64:67]
  ds_read_b64_tr_b16 v[138:139], v18 offset:50432
  ds_read_b64_tr_b16 v[140:141], v18 offset:49184
  v_mfma_f32_16x16x32_bf16 v[68:71], v[172:175], v[112:115], v[68:71]
  ds_read_b64_tr_b16 v[142:143], v18 offset:50464
  ds_read_b64_tr_b16 v[144:145], v19 offset:49152
  v_mfma_f32_16x16x32_bf16 v[72:75], v[116:119], v[168:171], v[72:75]
  ds_read_b64_tr_b16 v[146:147], v19 offset:49664
  ds_read_b64_tr_b16 v[148:149], v20 offset:49152
  v_mfma_f32_16x16x32_bf16 v[76:79], v[116:119], v[172:175], v[76:79]
  ds_read_b64_tr_b16 v[150:151], v20 offset:49664
  v_mfma_f32_16x16x32_bf16 v[80:83], v[120:123], v[168:171], v[80:83]
  s_add_u32 s19, s19, 1
  s_lshr_b32 s62, s49, s19
  v_mfma_f32_16x16x32_bf16 v[84:87], v[120:123], v[172:175], v[84:87]
  s_and_b32 vcc_lo, s62, 1
  s_bitcmp1_b32 s47, s19
  s_cbranch_scc1 K1_KVL_XT2
K1_KVL_XT2_B:
  s_waitcnt vmcnt(12) lgkmcnt(0)
  s_barrier
  s_cbranch_vccnz K1_KVL_HK3
K1_KVL_HK3_B:
  v_mfma_f32_16x16x32_bf16 v[32:35], v[176:179], v[124:127], v[32:35]
  s_add_u32 m0, s53, 49152
  s_nop 0
  buffer_load_dwordx4 v248, s[24:27], s51 offen lds
  s_add_u32 m0, s54, 49152
  s_nop 0
  buffer_load_dwordx4 v249, s[24:27], s51 offen lds
  v_mfma_f32_16x16x32_bf16 v[36:39], v[180:183], v[124:127], v[36:39]
  s_add_u32 m0, s36, 49152
  s_nop 0
  buffer_load_dwordx4 v250, s[24:27], s51 offen lds
  s_add_u32 m0, s37, 49152
  s_nop 0
  buffer_load_dwordx4 v251, s[24:27], s51 offen lds
  s_add_u32 s51, s51, s52
  v_mfma_f32_16x16x32_bf16 v[40:43], v[176:179], v[128:131], v[40:43]
  s_cmp_eq_u32 s51, s56
  s_cselect_b32 s51, 0, s51
  ds_read_b64_tr_b16 v[96:97], v16 offset:0
  v_mfma_f32_16x16x32_bf16 v[44:47], v[180:183], v[128:131], v[44:47]
  ds_read_b64_tr_b16 v[98:99], v16 offset:1280
  ds_read_b64_tr_b16 v[100:101], v16 offset:32
  v_mfma_f32_16x16x32_bf16 v[48:51], v[176:179], v[132:135], v[48:51]
  ds_read_b64_tr_b16 v[102:103], v16 offset:1312
  ds_read_b64_tr_b16 v[104:105], v17 offset:0
  v_mfma_f32_16x16x32_bf16 v[52:55], v[180:183], v[132:135], v[52:55]
  ds_read_b64_tr_b16 v[106:107], v17 offset:1280
  ds_read_b64_tr_b16 v[108:109], v18 offset:0
  v_mfma_f32_16x16x32_bf16 v[56:59], v[176:179], v[136:139], v[56:59]
  ds_read_b64_tr_b16 v[110:111], v18 offset:1280
  ds_read_b64_tr_b16 v[112:113], v18 offset:32
  v_mfma_f32_16x16x32_bf16 v[60:63], v[180:183], v[136:139], v[60:63]
  ds_read_b64_tr_b16 v[114:115], v18 offset:1312
  ds_read_b64_tr_b16 v[116:117], v19 offset:0
  v_mfma_f32_16x16x32_bf16 v[64:67], v[176:179], v[140:143], v[64:67]
  ds_read_b64_tr_b16 v[118:119], v19 offset:512
  ds_read_b64_tr_b16 v[120:121], v20 offset:0
  v_mfma_f32_16x16x32_bf16 v[68:71], v[180:183], v[140:143], v[68:71]
  ds_read_b64_tr_b16 v[122:123], v20 offset:512
  ds_read_b128 v[152:155], v21 offset:0
  v_mfma_f32_16x16x32_bf16 v[72:75], v[144:147], v[176:179], v[72:75]
  ds_read_b128 v[156:159], v22 offset:0
  ds_read_b128 v[160:163], v23 offset:0
  v_mfma_f32_16x16x32_bf16 v[76:79], v[144:147], v[180:183], v[76:79]
  ds_read_b128 v[164:167], v24 offset:0
  v_mfma_f32_16x16x32_bf16 v[80:83], v[148:151], v[176:179], v[80:83]
  s_add_u32 s19, s19, 1
  s_lshr_b32 s62, s49, s19
  v_mfma_f32_16x16x32_bf16 v[84:87], v[148:151], v[180:183], v[84:87]
  s_and_b32 vcc_lo, s62, 1
  s_bitcmp1_b32 s47, s19
  s_cbranch_scc1 K1_KVL_XT3
K1_KVL_XT3_B:
  s_waitcnt vmcnt(12) lgkmcnt(0)
  s_cmp_lt_u32 s19, 16
  s_cbranch_scc1 K1_KVL_LOOP
  s_barrier
  v_mfma_f32_16x16x32_bf16 v[32:35], v[152:155], v[96:99], v[32:35]
  ds_read_b64_tr_b16 v[124:125], v16 offset:16384
  v_mfma_f32_16x16x32_bf16 v[36:39], v[156:159], v[96:99], v[36:39]
  ds_read_b64_tr_b16 v[126:127], v16 offset:17664
  v_mfma_f32_16x16x32_bf16 v[40:43], v[152:155], v[100:103], v[40:43]
  ds_read_b64_tr_b16 v[128:129], v16 offset:16416
  v_mfma_f32_16x16x32_bf16 v[44:47], v[156:159], v[100:103], v[44:47]
  ds_read_b64_tr_b16 v[130:131], v16 offset:17696
  v_mfma_f32_16x16x32_bf16 v[48:51], v[152:155], v[104:107], v[48:51]
  ds_read_b64_tr_b16 v[132:133], v17 offset:16384
  v_mfma_f32_16x16x32_bf16 v[52:55], v[156:159], v[104:107], v[52:55]
  ds_read_b64_tr_b16 v[134:135], v17 offset:17664
  v_mfma_f32_16x16x32_bf16 v[56:59], v[152:155], v[108:111], v[56:59]
  ds_read_b64_tr_b16 v[136:137], v18 offset:16384
  v_mfma_f32_16x16x32_bf16 v[60:63], v[156:159], v[108:111], v[60:63]
  ds_read_b64_tr_b16 v[138:139], v18 offset:17664
  v_mfma_f32_16x16x32_bf16 v[64:67], v[152:155], v[112:115], v[64:67]
  ds_read_b64_tr_b16 v[140:141], v18 offset:16416
  v_mfma_f32_16x16x32_bf16 v[68:71], v[156:159], v[112:115], v[68:71]
  ds_read_b64_tr_b16 v[142:143], v18 offset:17696
  v_mfma_f32_16x16x32_bf16 v[72:75], v[116:119], v[152:155], v[72:75]
  ds_read_b64_tr_b16 v[144:145], v19 offset:16384
  v_mfma_f32_16x16x32_bf16 v[76:79], v[116:119], v[156:159], v[76:79]
  ds_read_b64_tr_b16 v[146:147], v19 offset:16896
  v_mfma_f32_16x16x32_bf16 v[80:83], v[120:123], v[152:155], v[80:83]
  ds_read_b64_tr_b16 v[148:149], v20 offset:16384
  v_mfma_f32_16x16x32_bf16 v[84:87], v[120:123], v[156:159], v[84:87]
  ds_read_b64_tr_b16 v[150:151], v20 offset:16896
  s_waitcnt vmcnt(4) lgkmcnt(0)
  s_barrier
  v_mfma_f32_16x16x32_bf16 v[32:35], v[160:163], v[124:127], v[32:35]
  ds_read_b64_tr_b16 v[96:97], v16 offset:32768
  ds_read_b64_tr_b16 v[98:99], v16 offset:34048
  v_mfma_f32_16x16x32_bf16 v[36:39], v[164:167], v[124:127], v[36:39]
  ds_read_b64_tr_b16 v[100:101], v16 offset:32800
  ds_read_b64_tr_b16 v[102:103], v16 offset:34080
  v_mfma_f32_16x16x32_bf16 v[40:43], v[160:163], v[128:131], v[40:43]
  ds_read_b64_tr_b16 v[104:105], v17 offset:32768
  ds_read_b64_tr_b16 v[106:107], v17 offset:34048
  v_mfma_f32_16x16x32_bf16 v[44:47], v[164:167], v[128:131], v[44:47]
  ds_read_b64_tr_b16 v[108:109], v18 offset:32768
  ds_read_b64_tr_b16 v[110:111], v18 offset:34048
  v_mfma_f32_16x16x32_bf16 v[48:51], v[160:163], v[132:135], v[48:51]
  ds_read_b64_tr_b16 v[112:113], v18 offset:32800
  v_mfma_f32_16x16x32_bf16 v[52:55], v[164:167], v[132:135], v[52:55]
  ds_read_b64_tr_b16 v[114:115], v18 offset:34080
  v_mfma_f32_16x16x32_bf16 v[56:59], v[160:163], v[136:139], v[56:59]
  ds_read_b64_tr_b16 v[116:117], v19 offset:32768
  v_mfma_f32_16x16x32_bf16 v[60:63], v[164:167], v[136:139], v[60:63]
  ds_read_b64_tr_b16 v[118:119], v19 offset:33280
  v_mfma_f32_16x16x32_bf16 v[64:67], v[160:163], v[140:143], v[64:67]
  ds_read_b64_tr_b16 v[120:121], v20 offset:32768
  v_mfma_f32_16x16x32_bf16 v[68:71], v[164:167], v[140:143], v[68:71]
  ds_read_b64_tr_b16 v[122:123], v20 offset:33280
  v_mfma_f32_16x16x32_bf16 v[72:75], v[144:147], v[160:163], v[72:75]
  ds_read_b128 v[168:171], v21 offset:16384
  v_mfma_f32_16x16x32_bf16 v[76:79], v[144:147], v[164:167], v[76:79]
  ds_read_b128 v[172:175], v22 offset:16384
  v_mfma_f32_16x16x32_bf16 v[80:83], v[148:151], v[160:163], v[80:83]
  ds_read_b128 v[176:179], v23 offset:16384
  v_mfma_f32_16x16x32_bf16 v[84:87], v[148:151], v[164:167], v[84:87]
  ds_read_b128 v[180:183], v24 offset:16384
  s_waitcnt vmcnt(0) lgkmcnt(0)
  s_barrier
  v_mfma_f32_16x16x32_bf16 v[32:35], v[168:171], v[96:99], v[32:35]
  ds_read_b64_tr_b16 v[124:125], v16 offset:49152
  v_mfma_f32_16x16x32_bf16 v[36:39], v[172:175], v[96:99], v[36:39]
  ds_read_b64_tr_b16 v[126:127], v16 offset:50432
  v_mfma_f32_16x16x32_bf16 v[40:43], v[168:171], v[100:103], v[40:43]
  ds_read_b64_tr_b16 v[128:129], v16 offset:49184
  v_mfma_f32_16x16x32_bf16 v[44:47], v[172:175], v[100:103], v[44:47]
  ds_read_b64_tr_b16 v[130:131], v16 offset:50464
  v_mfma_f32_16x16x32_bf16 v[48:51], v[168:171], v[104:107], v[48:51]
  ds_read_b64_tr_b16 v[132:133], v17 offset:49152
  v_mfma_f32_16x16x32_bf16 v[52:55], v[172:175], v[104:107], v[52:55]
  ds_read_b64_tr_b16 v[134:135], v17 offset:50432
  v_mfma_f32_16x16x32_bf16 v[56:59], v[168:171], v[108:111], v[56:59]
  ds_read_b64_tr_b16 v[136:137], v18 offset:49152
  v_mfma_f32_16x16x32_bf16 v[60:63], v[172:175], v[108:111], v[60:63]
  ds_read_b64_tr_b16 v[138:139], v18 offset:50432
  v_mfma_f32_16x16x32_bf16 v[64:67], v[168:171], v[112:115], v[64:67]
  ds_read_b64_tr_b16 v[140:141], v18 offset:49184
  v_mfma_f32_16x16x32_bf16 v[68:71], v[172:175], v[112:115], v[68:71]
  ds_read_b64_tr_b16 v[142:143], v18 offset:50464
  v_mfma_f32_16x16x32_bf16 v[72:75], v[116:119], v[168:171], v[72:75]
  ds_read_b64_tr_b16 v[144:145], v19 offset:49152
  v_mfma_f32_16x16x32_bf16 v[76:79], v[116:119], v[172:175], v[76:79]
  ds_read_b64_tr_b16 v[146:147], v19 offset:49664
  v_mfma_f32_16x16x32_bf16 v[80:83], v[120:123], v[168:171], v[80:83]
  ds_read_b64_tr_b16 v[148:149], v20 offset:49152
  v_mfma_f32_16x16x32_bf16 v[84:87], v[120:123], v[172:175], v[84:87]
  ds_read_b64_tr_b16 v[150:151], v20 offset:49664
  s_waitcnt lgkmcnt(0)
  s_barrier
  v_mfma_f32_16x16x32_bf16 v[32:35], v[176:179], v[124:127], v[32:35]
  v_mfma_f32_16x16x32_bf16 v[36:39], v[180:183], v[124:127], v[36:39]
  v_mfma_f32_16x16x32_bf16 v[40:43], v[176:179], v[128:131], v[40:43]
  v_mfma_f32_16x16x32_bf16 v[44:47], v[180:183], v[128:131], v[44:47]
  v_mfma_f32_16x16x32_bf16 v[48:51], v[176:179], v[132:135], v[48:51]
  v_mfma_f32_16x16x32_bf16 v[52:55], v[180:183], v[132:135], v[52:55]
  v_mfma_f32_16x16x32_bf16 v[56:59], v[176:179], v[136:139], v[56:59]
  v_mfma_f32_16x16x32_bf16 v[60:63], v[180:183], v[136:139], v[60:63]
  v_mfma_f32_16x16x32_bf16 v[64:67], v[176:179], v[140:143], v[64:67]
  v_mfma_f32_16x16x32_bf16 v[68:71], v[180:183], v[140:143], v[68:71]
  v_mfma_f32_16x16x32_bf16 v[72:75], v[144:147], v[176:179], v[72:75]
  v_mfma_f32_16x16x32_bf16 v[76:79], v[144:147], v[180:183], v[76:79]
  v_mfma_f32_16x16x32_bf16 v[80:83], v[148:151], v[176:179], v[80:83]
  v_mfma_f32_16x16x32_bf16 v[84:87], v[148:151], v[180:183], v[84:87]
  s_nop 0
  s_branch K1_KV_EPI
K1_KVS_LOOP:
  s_barrier
  s_cbranch_vccnz K1_KVS_HK0
K1_KVS_HK0_B:
  v_mfma_f32_16x16x32_bf16 v[32:35], v[152:155], v[96:99], v[32:35]
  ds_read_b64_tr_b16 v[124:125], v16 offset:16384
  ds_read_b64_tr_b16 v[126:127], v16 offset:17664
  v_mfma_f32_16x16x32_bf16 v[36:39], v[156:159], v[96:99], v[36:39]
  ds_read_b64_tr_b16 v[128:129], v16 offset:16416
  ds_read_b64_tr_b16 v[130:131], v16 offset:17696
  v_mfma_f32_16x16x32_bf16 v[40:43], v[152:155], v[100:103], v[40:43]
  ds_read_b64_tr_b16 v[132:133], v17 offset:16384
  v_mfma_f32_16x16x32_bf16 v[44:47], v[156:159], v[100:103], v[44:47]
  ds_read_b64_tr_b16 v[134:135], v17 offset:17664
  v_mfma_f32_16x16x32_bf16 v[48:51], v[152:155], v[104:107], v[48:51]
  ds_read_b64_tr_b16 v[136:137], v18 offset:16384
  v_mfma_f32_16x16x32_bf16 v[52:55], v[156:159], v[104:107], v[52:55]
  ds_read_b64_tr_b16 v[138:139], v18 offset:17664
  v_mfma_f32_16x16x32_bf16 v[56:59], v[152:155], v[108:111], v[56:59]
  ds_read_b64_tr_b16 v[140:141], v18 offset:16416
  v_mfma_f32_16x16x32_bf16 v[60:63], v[156:159], v[108:111], v[60:63]
  ds_read_b64_tr_b16 v[142:143], v18 offset:17696
  v_mfma_f32_16x16x32_bf16 v[64:67], v[152:155], v[112:115], v[64:67]
  ds_read_b64_tr_b16 v[144:145], v19 offset:16384
  v_mfma_f32_16x16x32_bf16 v[68:71], v[156:159], v[112:115], v[68:71]
  ds_read_b64_tr_b16 v[146:147], v19 offset:16896
  v_mfma_f32_16x16x32_bf16 v[72:75], v[116:119], v[152:155], v[72:75]
  ds_read_b64_tr_b16 v[148:149], v20 offset:16384
  v_mfma_f32_16x16x32_bf16 v[76:79], v[116:119], v[156:159], v[76:79]
  ds_read_b64_tr_b16 v[150:151], v20 offset:16896
  v_mfma_f32_16x16x32_bf16 v[80:83], v[120:123], v[152:155], v[80:83]
  s_add_u32 s19, s19, 1
  s_lshr_b32 s62, s49, s19
  v_mfma_f32_16x16x32_bf16 v[84:87], v[120:123], v[156:159], v[84:87]
  s_and_b32 vcc_lo, s62, 1
  s_bitcmp1_b32 s47, s19
  s_cbranch_scc1 K1_KVS_XT0
K1_KVS_XT0_B:
  s_waitcnt lgkmcnt(0)
  s_barrier
  s_cbranch_vccnz K1_KVS_HK1
K1_KVS_HK1_B:
  v_mfma_f32_16x16x32_bf16 v[32:35], v[160:163], v[124:127], v[32:35]
  ds_read_b64_tr_b16 v[96:97], v16 offset:32768
  ds_read_b64_tr_b16 v[98:99], v16 offset:34048
  v_mfma_f32_16x16x32_bf16 v[36:39], v[164:167], v[124:127], v[36:39]
  ds_read_b64_tr_b16 v[100:101], v16 offset:32800
  ds_read_b64_tr_b16 v[102:103], v16 offset:34080
  v_mfma_f32_16x16x32_bf16 v[40:43], v[160:163], v[128:131], v[40:43]
  ds_read_b64_tr_b16 v[104:105], v17 offset:32768
  ds_read_b64_tr_b16 v[106:107], v17 offset:34048
  v_mfma_f32_16x16x32_bf16 v[44:47], v[164:167], v[128:131], v[44:47]
  ds_read_b64_tr_b16 v[108:109], v18 offset:32768
  ds_read_b64_tr_b16 v[110:111], v18 offset:34048
  v_mfma_f32_16x16x32_bf16 v[48:51], v[160:163], v[132:135], v[48:51]
  ds_read_b64_tr_b16 v[112:113], v18 offset:32800
  ds_read_b64_tr_b16 v[114:115], v18 offset:34080
  v_mfma_f32_16x16x32_bf16 v[52:55], v[164:167], v[132:135], v[52:55]
  ds_read_b64_tr_b16 v[116:117], v19 offset:32768
  ds_read_b64_tr_b16 v[118:119], v19 offset:33280
  v_mfma_f32_16x16x32_bf16 v[56:59], v[160:163], v[136:139], v[56:59]
  ds_read_b64_tr_b16 v[120:121], v20 offset:32768
  v_mfma_f32_16x16x32_bf16 v[60:63], v[164:167], v[136:139], v[60:63]
  ds_read_b64_tr_b16 v[122:123], v20 offset:33280
  v_mfma_f32_16x16x32_bf16 v[64:67], v[160:163], v[140:143], v[64:67]
  ds_read_b128 v[168:171], v21 offset:16384
  v_mfma_f32_16x16x32_bf16 v[68:71], v[164:167], v[140:143], v[68:71]
  ds_read_b128 v[172:175], v22 offset:16384
  v_mfma_f32_16x16x32_bf16 v[72:75], v[144:147], v[160:163], v[72:75]
  ds_read_b128 v[176:179], v23 offset:16384
  v_mfma_f32_16x16x32_bf16 v[76:79], v[144:147], v[164:167], v[76:79]
  ds_read_b128 v[180:183], v24 offset:16384
  v_mfma_f32_16x16x32_bf16 v[80:83], v[148:151], v[160:163], v[80:83]
  s_add_u32 s19, s19, 1
  s_lshr_b32 s62, s49, s19
  v_mfma_f32_16x16x32_bf16 v[84:87], v[148:151], v[164:167], v[84:87]
  s_and_b32 vcc_lo, s62, 1
  s_bitcmp1_b32 s47, s19
  s_cbranch_scc1 K1_KVS_XT1
K1_KVS_XT1_B:
  s_waitcnt lgkmcnt(0)
  s_barrier
  s_cbranch_vccnz K1_KVS_HK2
K1_KVS_HK2_B:
  v_mfma_f32_16x16x32_bf16 v[32:35], v[168:171], v[96:99], v[32:35]
  ds_read_b64_tr_b16 v[124:125], v16 offset:49152
  ds_read_b64_tr_b16 v[126:127], v16 offset:50432
  v_mfma_f32_16x16x32_bf16 v[36:39], v[172:175], v[96:99], v[36:39]
  ds_read_b64_tr_b16 v[128:129], v16 offset:49184
  ds_read_b64_tr_b16 v[130:131], v16 offset:50464
  v_mfma_f32_16x16x32_bf16 v[40:43], v[168:171], v[100:103], v[40:43]
  ds_read_b64_tr_b16 v[132:133], v17 offset:49152
  v_mfma_f32_16x16x32_bf16 v[44:47], v[172:175], v[100:103], v[44:47]
  ds_read_b64_tr_b16 v[134:135], v17 offset:50432
  v_mfma_f32_16x16x32_bf16 v[48:51], v[168:171], v[104:107], v[48:51]
  ds_read_b64_tr_b16 v[136:137], v18 offset:49152
  v_mfma_f32_16x16x32_bf16 v[52:55], v[172:175], v[104:107], v[52:55]
  ds_read_b64_tr_b16 v[138:139], v18 offset:50432
  v_mfma_f32_16x16x32_bf16 v[56:59], v[168:171], v[108:111], v[56:59]
  ds_read_b64_tr_b16 v[140:141], v18 offset:49184
  v_mfma_f32_16x16x32_bf16 v[60:63], v[172:175], v[108:111], v[60:63]
  ds_read_b64_tr_b16 v[142:143], v18 offset:50464
  v_mfma_f32_16x16x32_bf16 v[64:67], v[168:171], v[112:115], v[64:67]
  ds_read_b64_tr_b16 v[144:145], v19 offset:49152
  v_mfma_f32_16x16x32_bf16 v[68:71], v[172:175], v[112:115], v[68:71]
  ds_read_b64_tr_b16 v[146:147], v19 offset:49664
  v_mfma_f32_16x16x32_bf16 v[72:75], v[116:119], v[168:171], v[72:75]
  ds_read_b64_tr_b16 v[148:149], v20 offset:49152
  v_mfma_f32_16x16x32_bf16 v[76:79], v[116:119], v[172:175], v[76:79]
  ds_read_b64_tr_b16 v[150:151], v20 offset:49664
  v_mfma_f32_16x16x32_bf16 v[80:83], v[120:123], v[168:171], v[80:83]
  s_add_u32 s19, s19, 1
  s_lshr_b32 s62, s49, s19
  v_mfma_f32_16x16x32_bf16 v[84:87], v[120:123], v[172:175], v[84:87]
  s_and_b32 vcc_lo, s62, 1
  s_bitcmp1_b32 s47, s19
  s_cbranch_scc1 K1_KVS_XT2
K1_KVS_XT2_B:
  s_waitcnt lgkmcnt(0)
  s_barrier
  s_cbranch_vccnz K1_KVS_HK3
K1_KVS_HK3_B:
  v_mfma_f32_16x16x32_bf16 v[32:35], v[176:179], v[124:127], v[32:35]
  ds_read_b64_tr_b16 v[96:97], v16 offset:0
  ds_read_b64_tr_b16 v[98:99], v16 offset:1280
  v_mfma_f32_16x16x32_bf16 v[36:39], v[180:183], v[124:127], v[36:39]
  ds_read_b64_tr_b16 v[100:101], v16 offset:32
  ds_read_b64_tr_b16 v[102:103], v16 offset:1312
  v_mfma_f32_16x16x32_bf16 v[40:43], v[176:179], v[128:131], v[40:43]
  ds_read_b64_tr_b16 v[104:105], v17 offset:0
  ds_read_b64_tr_b16 v[106:107], v17 offset:1280
  v_mfma_f32_16x16x32_bf16 v[44:47], v[180:183], v[128:131], v[44:47]
  ds_read_b64_tr_b16 v[108:109], v18 offset:0
  ds_read_b64_tr_b16 v[110:111], v18 offset:1280
  v_mfma_f32_16x16x32_bf16 v[48:51], v[176:179], v[132:135], v[48:51]
  ds_read_b64_tr_b16 v[112:113], v18 offset:32
  ds_read_b64_tr_b16 v[114:115], v18 offset:1312
  v_mfma_f32_16x16x32_bf16 v[52:55], v[180:183], v[132:135], v[52:55]
  ds_read_b64_tr_b16 v[116:117], v19 offset:0
  ds_read_b64_tr_b16 v[118:119], v19 offset:512
  v_mfma_f32_16x16x32_bf16 v[56:59], v[176:179], v[136:139], v[56:59]
  ds_read_b64_tr_b16 v[120:121], v20 offset:0
  v_mfma_f32_16x16x32_bf16 v[60:63], v[180:183], v[136:139], v[60:63]
  ds_read_b64_tr_b16 v[122:123], v20 offset:512
  v_mfma_f32_16x16x32_bf16 v[64:67], v[176:179], v[140:143], v[64:67]
  ds_read_b128 v[152:155], v21 offset:0
  v_mfma_f32_16x16x32_bf16 v[68:71], v[180:183], v[140:143], v[68:71]
  ds_read_b128 v[156:159], v22 offset:0
  v_mfma_f32_16x16x32_bf16 v[72:75], v[144:147], v[176:179], v[72:75]
  ds_read_b128 v[160:163], v23 offset:0
  v_mfma_f32_16x16x32_bf16 v[76:79], v[144:147], v[180:183], v[76:79]
  ds_read_b128 v[164:167], v24 offset:0
  v_mfma_f32_16x16x32_bf16 v[80:83], v[148:151], v[176:179], v[80:83]
  s_add_u32 s19, s19, 1
  s_lshr_b32 s62, s49, s19
  v_mfma_f32_16x16x32_bf16 v[84:87], v[148:151], v[180:183], v[84:87]
  s_and_b32 vcc_lo, s62, 1
  s_bitcmp1_b32 s47, s19
  s_cbranch_scc1 K1_KVS_XT3
K1_KVS_XT3_B:
  s_waitcnt lgkmcnt(0)
  s_cmp_lt_u32 s19, 16
  s_cbranch_scc1 K1_KVS_LOOP
  s_barrier
  s_waitcnt vmcnt(0)
  v_add_f32 v200, v200, v210
  v_add_f32 v201, v201, v211
  v_add_f32 v202, v202, v212
  v_add_f32 v203, v203, v213
  v_add_f32 v204, v204, v214
  v_add_f32 v205, v205, v215
  v_add_f32 v206, v206, v216
  v_add_f32 v207, v207, v217
  v_add_f32 v208, v208, v218
  v_add_f32 v209, v209, v219
  v_add_f32 v200, v200, v202
  v_add_f32 v201, v201, v203
  v_add_f32 v204, v204, v206
  v_add_f32 v205, v205, v207
  v_add_f32 v200, v200, v208
  v_add_f32 v201, v201, v209
  v_add_f32 v200, v200, v204
  v_add_f32 v201, v201, v205
  s_and_b32 s62, s44, 1
  s_lshl_b32 s62, s62, 6
  v_add_u32 v11, s62, v1
  s_cmp_ge_u32 s44, 6
  s_cbranch_scc1 K1_KVS_FCS
  v_mul_f32 v200, 0x3acccccd, v200
  v_mul_f32 v9, 0x3acccccd, v201
  v_lshlrev_b32 v11, 2, v11
  v_fma_f32 v9, -v200, v200, v9
  v_add_u32 v11, 110592, v11
  v_max_f32 v9, 0, v9
  v_cvt_pk_bf16_f32 v10, v200, v9
  v_lshlrev_b32 v8, 16, v10
  v_and_b32 v9, 0xffff0000, v10
  v_add_f32 v9, 0x3727c5ac, v9
  v_sub_f32 v8, 0, v8
  v_cvt_pk_bf16_f32 v10, v9, v9
  v_lshlrev_b32 v9, 16, v10
  v_sqrt_f32 v9, v9
  s_nop 0
  v_cvt_pk_bf16_f32 v10, v9, v9
  v_lshlrev_b32 v9, 16, v10
  v_rcp_f32 v9, v9
  ds_write_b32 v11, v8
  ds_write_b32 v11, v9 offset:512
  s_branch K1_KVS_FDONE
K1_KVS_FCS:
  v_lshlrev_b32 v11, 3, v11
  v_add_u32 v11, 111616, v11
  ds_write_b64 v11, v[200:201]
K1_KVS_FDONE:
  v_mfma_f32_16x16x32_bf16 v[32:35], v[152:155], v[96:99], v[32:35]
  ds_read_b64_tr_b16 v[124:125], v16 offset:16384
  v_mfma_f32_16x16x32_bf16 v[36:39], v[156:159], v[96:99], v[36:39]
  ds_read_b64_tr_b16 v[126:127], v16 offset:17664
  v_mfma_f32_16x16x32_bf16 v[40:43], v[152:155], v[100:103], v[40:43]
  ds_read_b64_tr_b16 v[128:129], v16 offset:16416
  v_mfma_f32_16x16x32_bf16 v[44:47], v[156:159], v[100:103], v[44:47]
  ds_read_b64_tr_b16 v[130:131], v16 offset:17696
  v_mfma_f32_16x16x32_bf16 v[48:51], v[152:155], v[104:107], v[48:51]
  ds_read_b64_tr_b16 v[132:133], v17 offset:16384
  v_mfma_f32_16x16x32_bf16 v[52:55], v[156:159], v[104:107], v[52:55]
  ds_read_b64_tr_b16 v[134:135], v17 offset:17664
  v_mfma_f32_16x16x32_bf16 v[56:59], v[152:155], v[108:111], v[56:59]
  ds_read_b64_tr_b16 v[136:137], v18 offset:16384
  v_mfma_f32_16x16x32_bf16 v[60:63], v[156:159], v[108:111], v[60:63]
  ds_read_b64_tr_b16 v[138:139], v18 offset:17664
  v_mfma_f32_16x16x32_bf16 v[64:67], v[152:155], v[112:115], v[64:67]
  ds_read_b64_tr_b16 v[140:141], v18 offset:16416
  v_mfma_f32_16x16x32_bf16 v[68:71], v[156:159], v[112:115], v[68:71]
  ds_read_b64_tr_b16 v[142:143], v18 offset:17696
  v_mfma_f32_16x16x32_bf16 v[72:75], v[116:119], v[152:155], v[72:75]
  ds_read_b64_tr_b16 v[144:145], v19 offset:16384
  v_mfma_f32_16x16x32_bf16 v[76:79], v[116:119], v[156:159], v[76:79]
  ds_read_b64_tr_b16 v[146:147], v19 offset:16896
  v_mfma_f32_16x16x32_bf16 v[80:83], v[120:123], v[152:155], v[80:83]
  ds_read_b64_tr_b16 v[148:149], v20 offset:16384
  v_mfma_f32_16x16x32_bf16 v[84:87], v[120:123], v[156:159], v[84:87]
  ds_read_b64_tr_b16 v[150:151], v20 offset:16896
  s_waitcnt lgkmcnt(0)
  s_barrier
  v_mfma_f32_16x16x32_bf16 v[32:35], v[160:163], v[124:127], v[32:35]
  ds_read_b64_tr_b16 v[96:97], v16 offset:32768
  ds_read_b64_tr_b16 v[98:99], v16 offset:34048
  v_mfma_f32_16x16x32_bf16 v[36:39], v[164:167], v[124:127], v[36:39]
  ds_read_b64_tr_b16 v[100:101], v16 offset:32800
  ds_read_b64_tr_b16 v[102:103], v16 offset:34080
  v_mfma_f32_16x16x32_bf16 v[40:43], v[160:163], v[128:131], v[40:43]
  ds_read_b64_tr_b16 v[104:105], v17 offset:32768
  ds_read_b64_tr_b16 v[106:107], v17 offset:34048
  v_mfma_f32_16x16x32_bf16 v[44:47], v[164:167], v[128:131], v[44:47]
  ds_read_b64_tr_b16 v[108:109], v18 offset:32768
  ds_read_b64_tr_b16 v[110:111], v18 offset:34048
  v_mfma_f32_16x16x32_bf16 v[48:51], v[160:163], v[132:135], v[48:51]
  ds_read_b64_tr_b16 v[112:113], v18 offset:32800
  v_mfma_f32_16x16x32_bf16 v[52:55], v[164:167], v[132:135], v[52:55]
  ds_read_b64_tr_b16 v[114:115], v18 offset:34080
  v_mfma_f32_16x16x32_bf16 v[56:59], v[160:163], v[136:139], v[56:59]
  ds_read_b64_tr_b16 v[116:117], v19 offset:32768
  v_mfma_f32_16x16x32_bf16 v[60:63], v[164:167], v[136:139], v[60:63]
  ds_read_b64_tr_b16 v[118:119], v19 offset:33280
  v_mfma_f32_16x16x32_bf16 v[64:67], v[160:163], v[140:143], v[64:67]
  ds_read_b64_tr_b16 v[120:121], v20 offset:32768
  v_mfma_f32_16x16x32_bf16 v[68:71], v[164:167], v[140:143], v[68:71]
  ds_read_b64_tr_b16 v[122:123], v20 offset:33280
  v_mfma_f32_16x16x32_bf16 v[72:75], v[144:147], v[160:163], v[72:75]
  ds_read_b128 v[168:171], v21 offset:16384
  v_mfma_f32_16x16x32_bf16 v[76:79], v[144:147], v[164:167], v[76:79]
  ds_read_b128 v[172:175], v22 offset:16384
  v_mfma_f32_16x16x32_bf16 v[80:83], v[148:151], v[160:163], v[80:83]
  ds_read_b128 v[176:179], v23 offset:16384
  v_mfma_f32_16x16x32_bf16 v[84:87], v[148:151], v[164:167], v[84:87]
  ds_read_b128 v[180:183], v24 offset:16384
  s_waitcnt lgkmcnt(0)
  s_barrier
  s_cmp_eq_u32 s44, 7
  s_cbranch_scc0 K1_KVS_GDONE
  s_waitcnt vmcnt(0)
  s_mov_b32 s63, 2097152
K1_KVS_GALL_W:
  v_cmp_eq_u32 vcc, 16, v220
  s_sub_u32 s63, s63, 1
  s_cmp_eq_u32 s63, 0
  s_cbranch_scc1 K1_KVS_GDONE
  s_nop 0
  s_cmp_eq_u64 vcc, -1
  s_cbranch_scc1 K1_KVS_GDONE
  s_sleep 4
  v_and_b32 v10, 15, v1
  v_lshlrev_b32 v10, 7, v10
  s_mov_b32 s62, 16857088
  buffer_load_dword v220, v10, s[28:31], s62 offen sc1
  s_waitcnt vmcnt(0)
  s_branch K1_KVS_GALL_W
K1_KVS_GDONE:
  v_mfma_f32_16x16x32_bf16 v[32:35], v[168:171], v[96:99], v[32:35]
  ds_read_b64_tr_b16 v[124:125], v16 offset:49152
  v_mfma_f32_16x16x32_bf16 v[36:39], v[172:175], v[96:99], v[36:39]
  ds_read_b64_tr_b16 v[126:127], v16 offset:50432
  v_mfma_f32_16x16x32_bf16 v[40:43], v[168:171], v[100:103], v[40:43]
  ds_read_b64_tr_b16 v[128:129], v16 offset:49184
  v_mfma_f32_16x16x32_bf16 v[44:47], v[172:175], v[100:103], v[44:47]
  ds_read_b64_tr_b16 v[130:131], v16 offset:50464
  v_mfma_f32_16x16x32_bf16 v[48:51], v[168:171], v[104:107], v[48:51]
  ds_read_b64_tr_b16 v[132:133], v17 offset:49152
  v_mfma_f32_16x16x32_bf16 v[52:55], v[172:175], v[104:107], v[52:55]
  ds_read_b64_tr_b16 v[134:135], v17 offset:50432
  v_mfma_f32_16x16x32_bf16 v[56:59], v[168:171], v[108:111], v[56:59]
  ds_read_b64_tr_b16 v[136:137], v18 offset:49152
  v_mfma_f32_16x16x32_bf16 v[60:63], v[172:175], v[108:111], v[60:63]
  ds_read_b64_tr_b16 v[138:139], v18 offset:50432
  v_mfma_f32_16x16x32_bf16 v[64:67], v[168:171], v[112:115], v[64:67]
  ds_read_b64_tr_b16 v[140:141], v18 offset:49184
  v_mfma_f32_16x16x32_bf16 v[68:71], v[172:175], v[112:115], v[68:71]
  ds_read_b64_tr_b16 v[142:143], v18 offset:50464
  v_mfma_f32_16x16x32_bf16 v[72:75], v[116:119], v[168:171], v[72:75]
  ds_read_b64_tr_b16 v[144:145], v19 offset:49152
  v_mfma_f32_16x16x32_bf16 v[76:79], v[116:119], v[172:175], v[76:79]
  ds_read_b64_tr_b16 v[146:147], v19 offset:49664
  v_mfma_f32_16x16x32_bf16 v[80:83], v[120:123], v[168:171], v[80:83]
  ds_read_b64_tr_b16 v[148:149], v20 offset:49152
  v_mfma_f32_16x16x32_bf16 v[84:87], v[120:123], v[172:175], v[84:87]
  ds_read_b64_tr_b16 v[150:151], v20 offset:49664
  s_waitcnt lgkmcnt(0)
  s_barrier
  v_mfma_f32_16x16x32_bf16 v[32:35], v[176:179], v[124:127], v[32:35]
  v_mfma_f32_16x16x32_bf16 v[36:39], v[180:183], v[124:127], v[36:39]
  v_mfma_f32_16x16x32_bf16 v[40:43], v[176:179], v[128:131], v[40:43]
  v_mfma_f32_16x16x32_bf16 v[44:47], v[180:183], v[128:131], v[44:47]
  v_mfma_f32_16x16x32_bf16 v[48:51], v[176:179], v[132:135], v[48:51]
  v_mfma_f32_16x16x32_bf16 v[52:55], v[180:183], v[132:135], v[52:55]
  v_mfma_f32_16x16x32_bf16 v[56:59], v[176:179], v[136:139], v[56:59]
  v_mfma_f32_16x16x32_bf16 v[60:63], v[180:183], v[136:139], v[60:63]
  v_mfma_f32_16x16x32_bf16 v[64:67], v[176:179], v[140:143], v[64:67]
  v_mfma_f32_16x16x32_bf16 v[68:71], v[180:183], v[140:143], v[68:71]
  v_mfma_f32_16x16x32_bf16 v[72:75], v[144:147], v[176:179], v[72:75]
  v_mfma_f32_16x16x32_bf16 v[76:79], v[144:147], v[180:183], v[76:79]
  v_mfma_f32_16x16x32_bf16 v[80:83], v[148:151], v[176:179], v[80:83]
  v_mfma_f32_16x16x32_bf16 v[84:87], v[148:151], v[180:183], v[84:87]
  s_nop 0
K1_KV_EPI:
  s_barrier
  s_and_b32 s70, s44, 1
  s_lshr_b32 s71, s44, 1
  s_lshl_b32 s72, s71, 5
  v_lshrrev_b32 v16, 4, v1
  v_and_b32 v17, 15, v1
  s_xor_b32 s73, s70, 0
  s_lshl_b32 s73, s73, 4
  s_add_u32 s73, s73, s72
  s_lshl_b32 s73, s73, 2
  s_add_u32 s73, s73, 110592
  v_lshl_add_u32 v18, v16, 4, s73
  ds_read_b128 v[96:99], v18
  ds_read_b128 v[104:107], v18 offset:512
  v_lshl_add_u32 v19, v17, 2, s73
  ds_read2_b32 v[136:137], v19 offset1:128
  s_xor_b32 s73, s70, 1
  s_lshl_b32 s73, s73, 4
  s_add_u32 s73, s73, s72
  s_lshl_b32 s73, s73, 2
  s_add_u32 s73, s73, 110592
  v_lshl_add_u32 v18, v16, 4, s73
  ds_read_b128 v[100:103], v18
  ds_read_b128 v[108:111], v18 offset:512
  v_lshl_add_u32 v19, v17, 2, s73
  ds_read2_b32 v[138:139], v19 offset1:128
  s_lshl_b32 s73, s70, 9
  s_add_u32 s73, s73, 111616
  v_lshl_add_u32 v18, v17, 2, s73
  ds_read_b32 v120, v18 offset:0
  ds_read_b32 v121, v18 offset:64
  ds_read_b32 v122, v18 offset:128
  ds_read_b32 v123, v18 offset:192
  ds_read_b32 v124, v18 offset:256
  v_lshl_add_u32 v18, v16, 4, s73
  ds_read_b128 v[128:131], v18 offset:320
  ds_read_b128 v[132:135], v18 offset:384
  v_mov_b32 v255, 0x358637bd
  s_mov_b32 s78, 0x00ff00ff
  s_mov_b32 s79, 0x00ff00ff
  s_waitcnt lgkmcnt(0)
  v_mul_f32 v112, 0x3fb8aa3b, v104
  v_mul_f32 v140, 0.5, v104
  v_mul_f32 v113, 0x3fb8aa3b, v105
  v_mul_f32 v141, 0.5, v105
  v_mul_f32 v114, 0x3fb8aa3b, v106
  v_mul_f32 v142, 0.5, v106
  v_mul_f32 v115, 0x3fb8aa3b, v107
  v_mul_f32 v143, 0.5, v107
  v_mul_f32 v116, 0x3fb8aa3b, v108
  v_mul_f32 v144, 0.5, v108
  v_mul_f32 v117, 0x3fb8aa3b, v109
  v_mul_f32 v145, 0.5, v109
  v_mul_f32 v118, 0x3fb8aa3b, v110
  v_mul_f32 v146, 0.5, v110
  v_mul_f32 v119, 0x3fb8aa3b, v111
  v_mul_f32 v147, 0.5, v111
  v_mul_f32 v148, 0.5, v137
  v_mul_f32 v149, 0.5, v139
  s_lshl_b32 s72, s46, 1
  s_add_u32 s72, s72, s70
  s_mov_b32 s73, s72
  s_cmp_ge_u32 s72, 14
  s_cselect_b32 s67, 5, 0
  s_add_u32 s73, s73, s67
  s_cmp_ge_u32 s72, 28
  s_cselect_b32 s67, 5, 0
  s_add_u32 s73, s73, s67
  s_cmp_ge_u32 s72, 41
  s_cselect_b32 s67, 5, 0
  s_add_u32 s73, s73, s67
  s_lshl_b32 s61, s45, 1
  s_lshr_b32 s74, s71, 1
  s_add_u32 s61, s61, s74
  s_mul_i32 s74, s61, 74
  s_add_u32 s73, s73, s74
  s_lshl_b32 s73, s73, 2
  s_and_b32 s74, s71, 1
  s_lshl_b32 s74, s74, 1
  s_add_u32 s73, s73, s74
  v_lshlrev_b32 v16, 4, v1
  v_fmac_f32 v72, v128, v136
  v_fmac_f32 v73, v129, v136
  v_fmac_f32 v74, v130, v136
  v_fmac_f32 v75, v131, v136
  v_fmac_f32 v80, v132, v136
  v_fmac_f32 v81, v133, v136
  v_fmac_f32 v82, v134, v136
  v_fmac_f32 v83, v135, v136
  v_add_f32_e64 v72, v72, |v72|
  v_add_f32_e64 v73, v73, |v73|
  v_add_f32_e64 v74, v74, |v74|
  v_add_f32_e64 v75, v75, |v75|
  v_add_f32_e64 v80, v80, |v80|
  v_add_f32_e64 v81, v81, |v81|
  v_add_f32_e64 v82, v82, |v82|
  v_add_f32_e64 v83, v83, |v83|
  v_mul_f32 v72, v72, v148
  v_mul_f32 v73, v73, v148
  v_mul_f32 v74, v74, v148
  v_mul_f32 v75, v75, v148
  v_mul_f32 v80, v80, v148
  v_mul_f32 v81, v81, v148
  v_mul_f32 v82, v82, v148
  v_mul_f32 v83, v83, v148
  v_cvt_pk_bf16_f32 v172, v72, v73
  v_cvt_pk_bf16_f32 v173, v74, v75
  v_cvt_pk_bf16_f32 v174, v80, v81
  v_cvt_pk_bf16_f32 v175, v82, v83
  s_xor_b32 s74, s70, 0
  s_add_u32 s74, s74, s73
  s_lshl_b32 s74, s74, 10
  buffer_store_dwordx4 v[172:175], v16, s[28:31], s74 offen sc1
  v_fmac_f32 v76, v128, v138
  v_fmac_f32 v77, v129, v138
  v_fmac_f32 v78, v130, v138
  v_fmac_f32 v79, v131, v138
  v_fmac_f32 v84, v132, v138
  v_fmac_f32 v85, v133, v138
  v_fmac_f32 v86, v134, v138
  v_fmac_f32 v87, v135, v138
  v_add_f32_e64 v76, v76, |v76|
  v_add_f32_e64 v77, v77, |v77|
  v_add_f32_e64 v78, v78, |v78|
  v_add_f32_e64 v79, v79, |v79|
  v_add_f32_e64 v84, v84, |v84|
  v_add_f32_e64 v85, v85, |v85|
  v_add_f32_e64 v86, v86, |v86|
  v_add_f32_e64 v87, v87, |v87|
  v_mul_f32 v76, v76, v149
  v_mul_f32 v77, v77, v149
  v_mul_f32 v78, v78, v149
  v_mul_f32 v79, v79, v149
  v_mul_f32 v84, v84, v149
  v_mul_f32 v85, v85, v149
  v_mul_f32 v86, v86, v149
  v_mul_f32 v87, v87, v149
  v_cvt_pk_bf16_f32 v176, v76, v77
  v_cvt_pk_bf16_f32 v177, v78, v79
  v_cvt_pk_bf16_f32 v178, v84, v85
  v_cvt_pk_bf16_f32 v179, v86, v87
  s_xor_b32 s74, s70, 1
  s_add_u32 s74, s74, s73
  s_lshl_b32 s74, s74, 10
  buffer_store_dwordx4 v[176:179], v16, s[28:31], s74 offen sc1
  v_fmac_f32 v32, v120, v96
  v_fmac_f32 v33, v120, v97
  v_fmac_f32 v34, v120, v98
  v_fmac_f32 v35, v120, v99
  v_fmac_f32 v36, v120, v100
  v_fmac_f32 v37, v120, v101
  v_fmac_f32 v38, v120, v102
  v_fmac_f32 v39, v120, v103
  v_mul_f32 v184, v32, v112
  v_mul_f32 v185, v33, v113
  v_mul_f32 v186, v34, v114
  v_mul_f32 v187, v35, v115
  v_mul_f32 v188, v36, v116
  v_mul_f32 v189, v37, v117
  v_mul_f32 v190, v38, v118
  v_mul_f32 v191, v39, v119
  v_exp_f32_e64 v184, v184 clamp
  v_add_f32_e64 v32, v32, |v32|
  v_exp_f32_e64 v185, v185 clamp
  v_add_f32_e64 v33, v33, |v33|
  v_exp_f32_e64 v186, v186 clamp
  v_add_f32_e64 v34, v34, |v34|
  v_exp_f32_e64 v187, v187 clamp
  v_add_f32_e64 v35, v35, |v35|
  v_exp_f32_e64 v188, v188 clamp
  v_add_f32_e64 v36, v36, |v36|
  v_exp_f32_e64 v189, v189 clamp
  v_add_f32_e64 v37, v37, |v37|
  v_exp_f32_e64 v190, v190 clamp
  v_add_f32_e64 v38, v38, |v38|
  v_exp_f32_e64 v191, v191 clamp
  v_add_f32_e64 v39, v39, |v39|
  v_add_f32 v184, v255, v184
  v_add_f32 v185, v255, v185
  v_add_f32 v186, v255, v186
  v_add_f32 v187, v255, v187
  v_add_f32 v188, v255, v188
  v_add_f32 v189, v255, v189
  v_add_f32 v190, v255, v190
  v_add_f32 v191, v255, v191
  v_fmac_f32 v184, v32, v140
  v_fmac_f32 v185, v33, v141
  v_fmac_f32 v186, v34, v142
  v_fmac_f32 v187, v35, v143
  v_fmac_f32 v188, v36, v144
  v_fmac_f32 v189, v37, v145
  v_fmac_f32 v190, v38, v146
  v_fmac_f32 v191, v39, v147
  v_cvt_pk_bf16_f32 v152, v184, v185
  v_cvt_pk_bf16_f32 v153, v186, v187
  v_cvt_pk_bf16_f32 v154, v188, v189
  v_cvt_pk_bf16_f32 v155, v190, v191
  v_fmac_f32 v40, v121, v96
  v_fmac_f32 v41, v121, v97
  v_fmac_f32 v42, v121, v98
  v_fmac_f32 v43, v121, v99
  v_fmac_f32 v44, v121, v100
  v_fmac_f32 v45, v121, v101
  v_fmac_f32 v46, v121, v102
  v_fmac_f32 v47, v121, v103
  v_mul_f32 v184, v40, v112
  v_mul_f32 v185, v41, v113
  v_mul_f32 v186, v42, v114
  v_mul_f32 v187, v43, v115
  v_mul_f32 v188, v44, v116
  v_mul_f32 v189, v45, v117
  v_mul_f32 v190, v46, v118
  v_mul_f32 v191, v47, v119
  v_exp_f32_e64 v184, v184 clamp
  v_add_f32_e64 v40, v40, |v40|
  v_exp_f32_e64 v185, v185 clamp
  v_add_f32_e64 v41, v41, |v41|
  v_exp_f32_e64 v186, v186 clamp
  v_add_f32_e64 v42, v42, |v42|
  v_exp_f32_e64 v187, v187 clamp
  v_add_f32_e64 v43, v43, |v43|
  v_exp_f32_e64 v188, v188 clamp
  v_add_f32_e64 v44, v44, |v44|
  v_exp_f32_e64 v189, v189 clamp
  v_add_f32_e64 v45, v45, |v45|
  v_exp_f32_e64 v190, v190 clamp
  v_add_f32_e64 v46, v46, |v46|
  v_exp_f32_e64 v191, v191 clamp
  v_add_f32_e64 v47, v47, |v47|
  v_add_f32 v184, v255, v184
  v_add_f32 v185, v255, v185
  v_add_f32 v186, v255, v186
  v_add_f32 v187, v255, v187
  v_add_f32 v188, v255, v188
  v_add_f32 v189, v255, v189
  v_add_f32 v190, v255, v190
  v_add_f32 v191, v255, v191
  v_fmac_f32 v184, v40, v140
  v_fmac_f32 v185, v41, v141
  v_fmac_f32 v186, v42, v142
  v_fmac_f32 v187, v43, v143
  v_fmac_f32 v188, v44, v144
  v_fmac_f32 v189, v45, v145
  v_fmac_f32 v190, v46, v146
  v_fmac_f32 v191, v47, v147
  v_cvt_pk_bf16_f32 v156, v184, v185
  v_cvt_pk_bf16_f32 v157, v186, v187
  v_cvt_pk_bf16_f32 v158, v188, v189
  v_cvt_pk_bf16_f32 v159, v190, v191
  v_fmac_f32 v48, v122, v96
  v_fmac_f32 v49, v122, v97
  v_fmac_f32 v50, v122, v98
  v_fmac_f32 v51, v122, v99
  v_fmac_f32 v52, v122, v100
  v_fmac_f32 v53, v122, v101
  v_fmac_f32 v54, v122, v102
  v_fmac_f32 v55, v122, v103
  v_mul_f32 v184, v48, v112
  v_mul_f32 v185, v49, v113
  v_mul_f32 v186, v50, v114
  v_mul_f32 v187, v51, v115
  v_mul_f32 v188, v52, v116
  v_mul_f32 v189, v53, v117
  v_mul_f32 v190, v54, v118
  v_mul_f32 v191, v55, v119
  v_mul_f32 v192, v48, v104
  v_mul_f32 v193, v49, v105
  v_mul_f32 v194, v50, v106
  v_mul_f32 v195, v51, v107
  v_mul_f32 v196, v52, v108
  v_mul_f32 v197, v53, v109
  v_mul_f32 v198, v54, v110
  v_mul_f32 v199, v55, v111
  v_exp_f32_e64 v184, v184 clamp
  v_add_f32_e64 v48, v48, |v48|
  v_exp_f32_e64 v185, v185 clamp
  v_add_f32_e64 v49, v49, |v49|
  v_exp_f32_e64 v186, v186 clamp
  v_add_f32_e64 v50, v50, |v50|
  v_exp_f32_e64 v187, v187 clamp
  v_add_f32_e64 v51, v51, |v51|
  v_exp_f32_e64 v188, v188 clamp
  v_add_f32_e64 v52, v52, |v52|
  v_exp_f32_e64 v189, v189 clamp
  v_add_f32_e64 v53, v53, |v53|
  v_exp_f32_e64 v190, v190 clamp
  v_add_f32_e64 v54, v54, |v54|
  v_exp_f32_e64 v191, v191 clamp
  v_add_f32_e64 v55, v55, |v55|
  v_add_f32 v184, v255, v184
  v_add_f32 v185, v255, v185
  v_add_f32 v186, v255, v186
  v_add_f32 v187, v255, v187
  v_add_f32 v188, v255, v188
  v_add_f32 v189, v255, v189
  v_add_f32 v190, v255, v190
  v_add_f32 v191, v255, v191
  v_fmac_f32 v184, v48, v140
  v_fmac_f32 v185, v49, v141
  v_fmac_f32 v186, v50, v142
  v_fmac_f32 v187, v51, v143
  v_fmac_f32 v188, v52, v144
  v_fmac_f32 v189, v53, v145
  v_fmac_f32 v190, v54, v146
  v_fmac_f32 v191, v55, v147
  v_cndmask_b32 v184, v192, v184, s[78:79]
  v_cndmask_b32 v185, v193, v185, s[78:79]
  v_cndmask_b32 v186, v194, v186, s[78:79]
  v_cndmask_b32 v187, v195, v187, s[78:79]
  v_cndmask_b32 v188, v196, v188, s[78:79]
  v_cndmask_b32 v189, v197, v189, s[78:79]
  v_cndmask_b32 v190, v198, v190, s[78:79]
  v_cndmask_b32 v191, v199, v191, s[78:79]
  v_cvt_pk_bf16_f32 v160, v184, v185
  v_cvt_pk_bf16_f32 v161, v186, v187
  v_cvt_pk_bf16_f32 v162, v188, v189
  v_cvt_pk_bf16_f32 v163, v190, v191
  v_fmac_f32 v56, v123, v96
  v_fmac_f32 v57, v123, v97
  v_fmac_f32 v58, v123, v98
  v_fmac_f32 v59, v123, v99
  v_fmac_f32 v60, v123, v100
  v_fmac_f32 v61, v123, v101
  v_fmac_f32 v62, v123, v102
  v_fmac_f32 v63, v123, v103
  v_mul_f32 v56, v56, v104
  v_mul_f32 v57, v57, v105
  v_mul_f32 v58, v58, v106
  v_mul_f32 v59, v59, v107
  v_mul_f32 v60, v60, v108
  v_mul_f32 v61, v61, v109
  v_mul_f32 v62, v62, v110
  v_mul_f32 v63, v63, v111
  v_cvt_pk_bf16_f32 v164, v56, v57
  v_cvt_pk_bf16_f32 v165, v58, v59
  v_cvt_pk_bf16_f32 v166, v60, v61
  v_cvt_pk_bf16_f32 v167, v62, v63
  v_fmac_f32 v64, v124, v96
  v_fmac_f32 v65, v124, v97
  v_fmac_f32 v66, v124, v98
  v_fmac_f32 v67, v124, v99
  v_fmac_f32 v68, v124, v100
  v_fmac_f32 v69, v124, v101
  v_fmac_f32 v70, v124, v102
  v_fmac_f32 v71, v124, v103
  v_mul_f32 v64, v64, v104
  v_mul_f32 v65, v65, v105
  v_mul_f32 v66, v66, v106
  v_mul_f32 v67, v67, v107
  v_mul_f32 v68, v68, v108
  v_mul_f32 v69, v69, v109
  v_mul_f32 v70, v70, v110
  v_mul_f32 v71, v71, v111
  v_cvt_pk_bf16_f32 v168, v64, v65
  v_cvt_pk_bf16_f32 v169, v66, v67
  v_cvt_pk_bf16_f32 v170, v68, v69
  v_cvt_pk_bf16_f32 v171, v70, v71
  v_mfma_f32_16x16x32_bf16 v[32:35], v[152:155], v[160:163], 0
  v_mfma_f32_16x16x32_bf16 v[36:39], v[152:155], v[164:167], 0
  v_mfma_f32_16x16x32_bf16 v[40:43], v[156:159], v[160:163], 0
  v_mfma_f32_16x16x32_bf16 v[44:47], v[156:159], v[164:167], 0
  v_mfma_f32_16x16x32_bf16 v[48:51], v[156:159], v[168:171], 0
  v_mfma_f32_16x16x32_bf16 v[52:55], v[160:163], v[164:167], 0
  v_mfma_f32_16x16x32_bf16 v[56:59], v[160:163], v[168:171], 0
  v_mfma_f32_16x16x32_bf16 v[60:63], v[152:155], v[12:15], 0
  v_mfma_f32_16x16x32_bf16 v[64:67], v[156:159], v[12:15], 0
  v_mfma_f32_16x16x32_bf16 v[68:71], v[160:163], v[12:15], 0
  s_mov_b32 exec_lo, 0xff00ff00
  s_mov_b32 exec_hi, 0xff00ff00
  ds_write_b128 v25, v[32:35] offset:0
  s_mov_b32 exec_lo, 0xfff0fff
  s_mov_b32 exec_hi, 0xfff0fff
  ds_write_b128 v25, v[36:39] offset:1280
  s_mov_b32 exec_lo, 0xff00
  s_mov_b32 exec_hi, 0x0
  ds_write_b128 v25, v[40:43] offset:64
  s_mov_b32 exec_lo, 0xf0000fff
  s_mov_b32 exec_hi, 0xf000f000
  ds_write_b128 v25, v[44:47] offset:1344
  s_mov_b32 exec_lo, 0xffff0000
  s_mov_b32 exec_hi, 0xffffffff
  ds_write_b128 v25, v[48:51] offset:2624
  s_mov_b32 exec_lo, 0xf000f000
  s_mov_b32 exec_hi, 0x0
  ds_write_b128 v25, v[52:55] offset:1408
  s_mov_b32 exec_lo, 0xffffffff
  s_mov_b32 exec_hi, 0x0
  ds_write_b128 v25, v[56:59] offset:2688
  s_mov_b32 exec_lo, 0x10001
  s_mov_b32 exec_hi, 0x10001
  ds_write_b128 v25, v[60:63] offset:2240
  s_mov_b32 exec_lo, 0x1
  s_mov_b32 exec_hi, 0x0
  ds_write_b128 v25, v[64:67] offset:2304
  s_mov_b32 exec_lo, 0x10000
  s_mov_b32 exec_hi, 0x10001
  ds_write_b128 v25, v[64:67] offset:3904
  s_mov_b32 exec_lo, 0x10001
  s_mov_b32 exec_hi, 0x0
  ds_write_b128 v25, v[68:71] offset:3968
  s_mov_b64 exec, -1
  s_waitcnt vmcnt(0)
  v_mov_b32 v10, 112640
  v_mov_b32 v11, 1
  s_mov_b64 exec, 1
  ds_add_rtn_u32 v8, v10, v11 offset:16
  s_mov_b64 exec, -1
  s_waitcnt lgkmcnt(0)
  v_readfirstlane_b32 s62, v8
  s_nop 3
  s_add_u32 s62, s62, 1
  s_cmp_eq_u32 s62, 8
  s_cbranch_scc0 K1_KV_SH
  s_lshl_b32 s62, s45, 7
  s_add_u32 s62, s62, 16846848
  s_mov_b64 exec, 1
  buffer_atomic_add v11, v31, s[28:31], s62 offen
  s_mov_b64 exec, -1
K1_KV_SH:
  s_waitcnt lgkmcnt(0)
  s_barrier
  s_mul_i32 s72, s46, 6720
  s_add_u32 s72, s72, 16777216
  s_add_u32 s40, s10, s72
  s_addc_u32 s41, s11, 0
  s_mov_b32 s42, 6720
  s_mov_b32 s43, 0x20000
  v_and_b32 v17, 511, v0
  v_lshlrev_b32 v17, 2, v17
  v_add_u32 v18, 32768, v17
  v_add_u32 v19, 4096, v17
  ds_read_b32 v32, v18 offset:0
  ds_read_b32 v33, v18 offset:6720
  ds_read_b32 v34, v18 offset:13440
  ds_read_b32 v35, v18 offset:20160
  ds_read_b32 v36, v18 offset:2048
  ds_read_b32 v37, v18 offset:8768
  ds_read_b32 v38, v18 offset:15488
  ds_read_b32 v39, v18 offset:22208
  ds_read_b32 v40, v18 offset:4096
  ds_read_b32 v41, v18 offset:10816
  ds_read_b32 v42, v18 offset:17536
  ds_read_b32 v43, v18 offset:24256
  s_waitcnt lgkmcnt(0)
  v_add_f32 v32, v32, v33
  v_add_f32 v34, v34, v35
  v_add_f32 v36, v36, v37
  v_add_f32 v38, v38, v39
  v_add_f32 v40, v40, v41
  v_add_f32 v42, v42, v43
  v_add_f32 v32, v32, v34
  v_add_f32 v36, v36, v38
  v_add_f32 v40, v40, v42
  buffer_atomic_add_f32 v32, v17, s[40:43], 0 offen offset:0
  buffer_atomic_add_f32 v36, v17, s[40:43], 0 offen offset:2048
  buffer_atomic_add_f32 v40, v19, s[40:43], 0 offen offset:0
  ds_read_b32 v44, v18 offset:6144
  ds_read_b32 v45, v18 offset:12864
  ds_read_b32 v46, v18 offset:19584
  ds_read_b32 v47, v18 offset:26304
  s_waitcnt lgkmcnt(0)
  v_add_f32 v44, v44, v45
  v_add_f32 v46, v46, v47
  v_add_f32 v44, v44, v46
  buffer_atomic_add_f32 v44, v19, s[40:43], 0 offen offset:2048
  s_waitcnt vmcnt(0)
  v_mov_b32 v10, 112640
  v_mov_b32 v11, 1
  s_mov_b64 exec, 1
  ds_add_rtn_u32 v8, v10, v11 offset:24
  s_mov_b64 exec, -1
  s_waitcnt lgkmcnt(0)
  v_readfirstlane_b32 s62, v8
  s_nop 3
  s_add_u32 s62, s62, 1
  s_cmp_eq_u32 s62, 8
  s_cbranch_scc0 K1_KV_SK
  s_lshl_b32 s62, s46, 9
  s_add_u32 s62, s62, 16848896
  v_lshlrev_b32 v10, 7, v1
  v_mov_b32 v11, 1
  s_mov_b64 exec, 15
  buffer_atomic_add v11, v10, s[28:31], s62 offen
  s_mov_b64 exec, -1
K1_KV_SK:
  s_branch PH2
K1_KVL_XT0:
  v_mfma_f32_16x16x32_bf16 v[200:203], v[12:15], v[96:99], v[200:203]
  v_mfma_f32_16x16x32_bf16 v[204:207], v[12:15], v[100:103], v[204:207]
  v_mfma_f32_16x16x32_bf16 v[208:211], v[12:15], v[104:107], v[208:211]
  v_mfma_f32_16x16x32_bf16 v[212:215], v[12:15], v[108:111], v[212:215]
  v_mfma_f32_16x16x32_bf16 v[216:219], v[12:15], v[112:115], v[216:219]
  v_mfma_f32_16x16x32_bf16 v[220:223], v[116:119], v[12:15], v[220:223]
  v_mfma_f32_16x16x32_bf16 v[224:227], v[120:123], v[12:15], v[224:227]
  v_mfma_f32_16x16x32_bf16 v[240:243], v[152:155], v[152:155], v[240:243]
  v_mfma_f32_16x16x32_bf16 v[244:247], v[12:15], v[152:155], v[244:247]
  s_branch K1_KVL_XT0_B
K1_KVL_XT1:
  v_mfma_f32_16x16x32_bf16 v[200:203], v[12:15], v[124:127], v[200:203]
  v_mfma_f32_16x16x32_bf16 v[204:207], v[12:15], v[128:131], v[204:207]
  v_mfma_f32_16x16x32_bf16 v[208:211], v[12:15], v[132:135], v[208:211]
  v_mfma_f32_16x16x32_bf16 v[212:215], v[12:15], v[136:139], v[212:215]
  v_mfma_f32_16x16x32_bf16 v[216:219], v[12:15], v[140:143], v[216:219]
  v_mfma_f32_16x16x32_bf16 v[220:223], v[144:147], v[12:15], v[220:223]
  v_mfma_f32_16x16x32_bf16 v[224:227], v[148:151], v[12:15], v[224:227]
  v_mfma_f32_16x16x32_bf16 v[240:243], v[160:163], v[160:163], v[240:243]
  v_mfma_f32_16x16x32_bf16 v[244:247], v[12:15], v[160:163], v[244:247]
  s_branch K1_KVL_XT1_B
K1_KVL_XT2:
  s_branch K1_KVL_XT2_B
K1_KVL_XT3:
  s_branch K1_KVL_XT3_B
K1_KVL_HK0:
  s_branch K1_KVL_HK0_B
K1_KVL_HK1:
  s_branch K1_KVL_HK1_B
K1_KVL_HK2:
  s_cmp_eq_u32 s19, 2
  s_cbranch_scc0 K1_KVL_HK2_a
  s_and_b32 s70, s44, 1
  s_lshr_b32 s71, s44, 1
  s_lshl_b32 s72, s71, 5
  s_lshl_b32 s73, s70, 4
  s_add_u32 s73, s73, s72
  s_mov_b32 s74, 0xaaaaaaaa
  s_mov_b32 s75, 0xaaaaaaaa
  s_mov_b32 s76, 0xcccccccc
  s_mov_b32 s77, 0xcccccccc
  v_cndmask_b32 v8, v240, v241, s[74:75]
  v_cndmask_b32 v9, v242, v243, s[74:75]
  v_and_b32 v10, 15, v1
  v_cndmask_b32 v9, v8, v9, s[76:77]
  v_mov_b32 v8, v244
  s_lshl_b32 s62, s73, 3
  s_add_u32 s62, s62, 110592
  v_lshl_add_u32 v10, v10, 3, s62
  s_mov_b32 exec_lo, 0xf0000f
  s_mov_b32 exec_hi, 0xf0000f00
  ds_write_b64 v10, v[8:9]
  s_mov_b64 exec, -1
  s_lshl_b32 s62, s70, 9
  s_add_u32 s62, s62, 111616
  v_and_b32 v10, 15, v1
  v_lshl_add_u32 v10, v10, 2, s62
  v_lshrrev_b32 v11, 4, v1
  v_lshl_add_u32 v11, v11, 4, s62
  s_mov_b32 exec_lo, 0xffff
  s_mov_b32 exec_hi, 0x0
  ds_write_b32 v10, v200 offset:0
  ds_write_b32 v10, v204 offset:64
  ds_write_b32 v10, v208 offset:128
  ds_write_b32 v10, v212 offset:192
  ds_write_b32 v10, v216 offset:256
  s_mov_b32 exec_lo, 0x10001
  s_mov_b32 exec_hi, 0x10001
  ds_write_b128 v11, v[220:223] offset:320
  ds_write_b128 v11, v[224:227] offset:384
  s_mov_b64 exec, -1
K1_KVL_HK2_a:
  s_branch K1_KVL_HK2_B
K1_KVL_HK3:
  s_branch K1_KVL_HK3_B
K1_KVS_XT0:
  v_mfma_f32_16x16x32_bf16 v[200:203], v[12:15], v[96:99], v[200:203]
  v_mfma_f32_16x16x32_bf16 v[204:207], v[12:15], v[100:103], v[204:207]
  v_mfma_f32_16x16x32_bf16 v[208:211], v[12:15], v[104:107], v[208:211]
  v_mfma_f32_16x16x32_bf16 v[212:215], v[12:15], v[108:111], v[212:215]
  v_mfma_f32_16x16x32_bf16 v[216:219], v[12:15], v[112:115], v[216:219]
  v_mfma_f32_16x16x32_bf16 v[220:223], v[116:119], v[12:15], v[220:223]
  v_mfma_f32_16x16x32_bf16 v[224:227], v[120:123], v[12:15], v[224:227]
  v_mfma_f32_16x16x32_bf16 v[240:243], v[152:155], v[152:155], v[240:243]
  v_mfma_f32_16x16x32_bf16 v[244:247], v[12:15], v[152:155], v[244:247]
  s_branch K1_KVS_XT0_B
K1_KVS_XT1:
  v_mfma_f32_16x16x32_bf16 v[200:203], v[12:15], v[124:127], v[200:203]
  v_mfma_f32_16x16x32_bf16 v[204:207], v[12:15], v[128:131], v[204:207]
  v_mfma_f32_16x16x32_bf16 v[208:211], v[12:15], v[132:135], v[208:211]
  v_mfma_f32_16x16x32_bf16 v[212:215], v[12:15], v[136:139], v[212:215]
  v_mfma_f32_16x16x32_bf16 v[216:219], v[12:15], v[140:143], v[216:219]
  v_mfma_f32_16x16x32_bf16 v[220:223], v[144:147], v[12:15], v[220:223]
  v_mfma_f32_16x16x32_bf16 v[224:227], v[148:151], v[12:15], v[224:227]
  v_mfma_f32_16x16x32_bf16 v[240:243], v[160:163], v[160:163], v[240:243]
  v_mfma_f32_16x16x32_bf16 v[244:247], v[12:15], v[160:163], v[244:247]
  s_branch K1_KVS_XT1_B
K1_KVS_XT2:
  s_branch K1_KVS_XT2_B
K1_KVS_XT3:
  s_branch K1_KVS_XT3_B
K1_KVS_HK0:
  s_cmp_eq_u32 s19, 12
  s_cbranch_scc0 K1_KVS_HK0_b
  s_waitcnt vmcnt(0)
  s_mov_b32 s63, 2097152
K1_KVS_HK0_CW:
  v_cmp_eq_u32 vcc, 16, v29
  s_sub_u32 s63, s63, 1
  s_cmp_eq_u32 s63, 0
  s_cbranch_scc1 K1_KVS_HK0_CG
  s_nop 0
  s_cmp_eq_u64 vcc, -1
  s_cbranch_scc1 K1_KVS_HK0_CG
  s_sleep 4
  buffer_load_dword v29, v28, s[28:31], 0 offen sc1
  s_waitcnt vmcnt(0)
  s_branch K1_KVS_HK0_CW
K1_KVS_HK0_CG:
  s_mov_b32 vcc_hi, 0
K1_KVS_HK0_b:
  s_branch K1_KVS_HK0_B
K1_KVS_HK1:
  s_cmp_eq_u32 s19, 13
  s_cbranch_scc0 K1_KVS_HK1_b
  s_and_b32 s62, s44, 1
  s_lshl_b32 s62, s62, 6
  v_add_u32 v11, s62, v1
  v_lshlrev_b32 v11, 3, v11
  s_lshl_b32 s62, s45, 14
  s_add_u32 s62, s62, 17432576
  s_lshl_b32 s63, s18, 14
  s_add_u32 s63, s63, 17694720
  s_cmp_lt_u32 s44, 6
  s_cselect_b32 s62, s62, s63
  buffer_load_dwordx2 v[200:201], v11, s[28:31], s62 offen offset:0 sc1
  buffer_load_dwordx2 v[202:203], v11, s[28:31], s62 offen offset:1024 sc1
  buffer_load_dwordx2 v[204:205], v11, s[28:31], s62 offen offset:2048 sc1
  buffer_load_dwordx2 v[206:207], v11, s[28:31], s62 offen offset:3072 sc1
  s_add_u32 s62, s62, 4096
  buffer_load_dwordx2 v[208:209], v11, s[28:31], s62 offen offset:0 sc1
  buffer_load_dwordx2 v[210:211], v11, s[28:31], s62 offen offset:1024 sc1
  buffer_load_dwordx2 v[212:213], v11, s[28:31], s62 offen offset:2048 sc1
  buffer_load_dwordx2 v[214:215], v11, s[28:31], s62 offen offset:3072 sc1
  s_add_u32 s62, s62, 4096
  buffer_load_dwordx2 v[216:217], v11, s[28:31], s62 offen offset:0 sc1
  buffer_load_dwordx2 v[218:219], v11, s[28:31], s62 offen offset:1024 sc1
  v_and_b32 v10, 15, v1
  v_lshlrev_b32 v10, 7, v10
  s_mov_b32 s62, 16857088
  buffer_load_dword v220, v10, s[28:31], s62 offen sc1
K1_KVS_HK1_b:
  s_cmp_eq_u32 s44, 7
  s_cbranch_scc0 K1_KVS_HK1_w7
  s_cmp_eq_u32 s19, 9
  s_cbranch_scc0 K1_KVS_HK1_g
  buffer_load_dword v29, v28, s[28:31], 0 offen sc1
K1_KVS_HK1_g:
K1_KVS_HK1_w7:
  s_branch K1_KVS_HK1_B
K1_KVS_HK2:
  s_cmp_eq_u32 s19, 2
  s_cbranch_scc0 K1_KVS_HK2_a
  s_and_b32 s70, s44, 1
  s_lshr_b32 s71, s44, 1
  s_lshl_b32 s72, s71, 5
  s_lshl_b32 s73, s70, 4
  s_add_u32 s73, s73, s72
  s_mov_b32 s74, 0xaaaaaaaa
  s_mov_b32 s75, 0xaaaaaaaa
  s_mov_b32 s76, 0xcccccccc
  s_mov_b32 s77, 0xcccccccc
  v_cndmask_b32 v8, v240, v241, s[74:75]
  v_cndmask_b32 v9, v242, v243, s[74:75]
  v_and_b32 v10, 15, v1
  v_cndmask_b32 v9, v8, v9, s[76:77]
  v_mov_b32 v8, v244
  s_lshl_b32 s62, s73, 3
  s_add_u32 s62, s62, 110592
  v_lshl_add_u32 v10, v10, 3, s62
  s_mov_b32 exec_lo, 0xf0000f
  s_mov_b32 exec_hi, 0xf0000f00
  ds_write_b64 v10, v[8:9]
  s_mov_b64 exec, -1
  s_lshl_b32 s62, s70, 9
  s_add_u32 s62, s62, 111616
  v_and_b32 v10, 15, v1
  v_lshl_add_u32 v10, v10, 2, s62
  v_lshrrev_b32 v11, 4, v1
  v_lshl_add_u32 v11, v11, 4, s62
  s_mov_b32 exec_lo, 0xffff
  s_mov_b32 exec_hi, 0x0
  ds_write_b32 v10, v200 offset:0
  ds_write_b32 v10, v204 offset:64
  ds_write_b32 v10, v208 offset:128
  ds_write_b32 v10, v212 offset:192
  ds_write_b32 v10, v216 offset:256
  s_mov_b32 exec_lo, 0x10001
  s_mov_b32 exec_hi, 0x10001
  ds_write_b128 v11, v[220:223] offset:320
  ds_write_b128 v11, v[224:227] offset:384
  s_mov_b64 exec, -1
K1_KVS_HK2_a:
  s_cmp_eq_u32 s44, 7
  s_cbranch_scc0 K1_KVS_HK2_w7
  s_cmp_eq_u32 s19, 6
  s_cbranch_scc0 K1_KVS_HK2_f
  s_waitcnt vmcnt(0)
  s_mov_b32 s63, 2097152
K1_KVS_HK2_W:
  v_readfirstlane_b32 s62, v30
  s_sub_u32 s63, s63, 1
  s_cmp_eq_u32 s63, 0
  s_cbranch_scc1 K1_KVS_HK2_G
  s_nop 0
  s_cmp_ge_u32 s62, 20
  s_cbranch_scc1 K1_KVS_HK2_G
  s_sleep 4
  buffer_load_dword v30, v31, s[32:35], 0 offen sc1
  s_waitcnt vmcnt(0)
  s_branch K1_KVS_HK2_W
K1_KVS_HK2_G:
  v_mov_b32 v10, 1
  s_mov_b64 exec, 3
  buffer_atomic_add v10, v28, s[28:31], 0 offen
  s_mov_b64 exec, -1
K1_KVS_HK2_f:
K1_KVS_HK2_w7:
  s_cmp_lt_u32 s60, 740
  s_cbranch_scc0 K1_KVS_HK2_B
  s_cmp_eq_u32 s19, 2
  s_cbranch_scc0 K1_KVS_HK2_d
  s_waitcnt vmcnt(0)
  v_lshrrev_b32 v252, 4, v1
  v_bfe_u32 v253, v1, 2, 2
  v_lshl_add_u32 v252, v252, 2, v253
  v_lshlrev_b32 v252, 7, v252
  v_and_b32 v253, 3, v1
  v_lshl_add_u32 v252, v253, 3, v252
  s_lshl_b32 s66, s44, 12
  s_add_u32 s66, s66, 81920
  v_add_u32 v252, s66, v252
  ds_read_b64_tr_b16 v[228:229], v252 offset:0
  ds_read_b64_tr_b16 v[230:231], v252 offset:2048
  ds_read_b64_tr_b16 v[232:233], v252 offset:32
  ds_read_b64_tr_b16 v[234:235], v252 offset:2080
  ds_read_b64_tr_b16 v[236:237], v252 offset:64
  ds_read_b64_tr_b16 v[238:239], v252 offset:2112
  ds_read_b64_tr_b16 v[248:249], v252 offset:96
  ds_read_b64_tr_b16 v[250:251], v252 offset:2144
  s_cmp_lt_u32 s98, 54
  s_cbranch_scc0 K1_KVS_HK2_JO
  s_mov_b32 s66, s98
  s_cmp_ge_u32 s98, 14
  s_cselect_b32 s67, 5, 0
  s_add_u32 s66, s66, s67
  s_cmp_ge_u32 s98, 28
  s_cselect_b32 s67, 5, 0
  s_add_u32 s66, s66, s67
  s_cmp_ge_u32 s98, 41
  s_cselect_b32 s67, 5, 0
  s_add_u32 s66, s66, s67
  s_branch K1_KVS_HK2_JS
K1_KVS_HK2_JO:
  s_add_u32 s66, s100, 14
  s_cmp_ge_u32 s100, 5
  s_cselect_b32 s67, 14, 0
  s_add_u32 s66, s66, s67
  s_cmp_ge_u32 s100, 10
  s_cselect_b32 s67, 13, 0
  s_add_u32 s66, s66, s67
  s_cmp_ge_u32 s100, 15
  s_cselect_b32 s67, 13, 0
  s_add_u32 s66, s66, s67
K1_KVS_HK2_JS:
  s_mul_i32 s66, s66, 40
  s_lshl_b32 s67, s99, 2
  s_add_u32 s66, s66, s67
  s_lshl_b32 s66, s66, 10
  s_add_u32 s66, s66, 13631488
  v_lshlrev_b32 v253, 4, v1
  s_waitcnt lgkmcnt(0)
  buffer_store_dwordx4 v[228:231], v253, s[28:31], s66 offen offset:0 sc1
  buffer_store_dwordx4 v[232:235], v253, s[28:31], s66 offen offset:1024 sc1
  buffer_store_dwordx4 v[236:239], v253, s[28:31], s66 offen offset:2048 sc1
  buffer_store_dwordx4 v[248:251], v253, s[28:31], s66 offen offset:3072 sc1
K1_KVS_HK2_d:
  s_cmp_eq_u32 s19, 6
  s_cbranch_scc0 K1_KVS_HK2_e
  s_waitcnt vmcnt(0)
K1_KVS_HK2_e:
  s_branch K1_KVS_HK2_B
K1_KVS_HK3:
  s_cmp_eq_u32 s19, 3
  s_cbranch_scc0 K1_KVS_HK3_b
  v_lshlrev_b32 v10, 4, v1
  v_add_u32 v11, 110592, v10
  ds_read_b128 v[228:231], v11
  ds_read_b128 v[232:235], v11 offset:1024
  s_lshl_b32 s62, s45, 4
  s_add_u32 s62, s62, s18
  s_lshl_b32 s62, s62, 10
  s_add_u32 s62, s62, 17432576
  s_lshl_b32 s63, s18, 4
  s_add_u32 s63, s63, s45
  s_lshl_b32 s63, s63, 10
  s_add_u32 s63, s63, 17694720
  s_waitcnt lgkmcnt(0)
  buffer_store_dwordx4 v[228:231], v10, s[28:31], s62 offen sc1
  buffer_store_dwordx4 v[232:235], v10, s[28:31], s63 offen sc1
  buffer_load_dword v30, v31, s[32:35], 0 offen sc1
K1_KVS_HK3_b:
  s_cmp_eq_u32 s19, 7
  s_cbranch_scc0 K1_KVS_HK3_c
  s_lshl_b32 s62, s45, 7
  s_add_u32 s62, s62, 16857088
  v_mov_b32 v10, 1
  s_mov_b64 exec, 1
  buffer_atomic_add v10, v31, s[28:31], s62 offen
  s_mov_b64 exec, -1
K1_KVS_HK3_c:
  s_branch K1_KVS_HK3_B
K1_HQ_NODMA:
  s_and_b32 s62, s44, 1
  s_lshr_b32 s63, s44, 1
  s_mov_b32 s28, s10
  s_mov_b32 s29, s11
  s_mov_b32 s30, 17956864
  s_mov_b32 s31, 0x20000
  s_mov_b32 s32, s12
  s_mov_b32 s33, s13
  s_mov_b32 s34, 256
  s_mov_b32 s35, 0x20000
  s_mov_b32 s64, 0x81800908
  s_cmp_eq_u32 s46, 1
  s_cselect_b32 s64, 0x83820b0a, s64
  s_cmp_eq_u32 s46, 2
  s_cselect_b32 s64, 0xe840d0c, s64
  s_cmp_eq_u32 s46, 3
  s_cselect_b32 s64, 0x1185100f, s64
  s_cmp_eq_u32 s46, 4
  s_cselect_b32 s64, 0x14861312, s64
  s_cmp_eq_u32 s46, 5
  s_cselect_b32 s64, 0x56871615, s64
  s_cmp_eq_u32 s46, 6
  s_cselect_b32 s64, 0x58881817, s64
  s_cmp_eq_u32 s46, 7
  s_cselect_b32 s64, 0x5a891a19, s64
  s_lshl_b32 s65, s63, 3
  s_lshr_b32 s64, s64, s65
  s_and_b32 s57, s64, 63
  s_bfe_u32 s58, s64, 0x10007
  s_bfe_u32 s59, s64, 0x10006
  s_cmp_ge_u32 s46, 5
  s_cselect_b32 s68, 1, 0
  s_cmp_lt_u32 s45, 7
  s_cselect_b32 s68, s68, 0
  s_cmp_eq_u32 s44, 6
  s_cselect_b32 s68, s68, 0
  s_sub_u32 s69, s46, 5
  s_mul_i32 s69, s69, 7
  s_add_u32 s69, s69, s45
  s_cmp_lt_u32 s69, 20
  s_cselect_b32 s68, s68, 0
  s_cmp_eq_u32 s68, 1
  s_cbranch_scc0 K1_NOZERO
  s_lshl_b32 s69, s69, 12
  s_add_u32 s69, s69, 16777216
  v_mov_b32 v32, 0
  v_mov_b32 v33, 0
  v_mov_b32 v34, 0
  v_mov_b32 v35, 0
  v_lshlrev_b32 v36, 4, v1
  buffer_store_dwordx4 v[32:35], v36, s[28:31], s69 offen offset:0 sc1
  buffer_store_dwordx4 v[32:35], v36, s[28:31], s69 offen offset:1024 sc1
  buffer_store_dwordx4 v[32:35], v36, s[28:31], s69 offen offset:2048 sc1
  buffer_store_dwordx4 v[32:35], v36, s[28:31], s69 offen offset:3072 sc1
K1_NOZERO:
  s_lshl_b32 s64, s62, 1
  s_lshl_b32 s66, s63, 12
  v_lshrrev_b32 v56, 4, v1
  v_bfe_u32 v57, v1, 2, 2
  v_bfe_u32 v58, v1, 1, 1
  v_lshrrev_b32 v59, 1, v57
  v_and_b32 v60, 1, v56
  v_lshl_or_b32 v59, v60, 1, v59
  v_lshlrev_b32 v59, 1, v59
  s_xor_b32 s48, s64, 0
  s_lshl_b32 s48, s48, 1
  v_or_b32 v60, s48, v58
  v_xor_b32 v60, v60, v59
  v_lshl_add_u32 v61, v56, 3, v57
  v_lshlrev_b32 v61, 7, v61
  v_lshl_add_u32 v61, v60, 4, v61
  v_and_b32 v60, 1, v1
  v_lshl_add_u32 v61, v60, 3, v61
  v_add_u32 v61, s66, v61
  v_mov_b32 v16, v61
  v_lshrrev_b32 v56, 4, v1
  v_bfe_u32 v57, v1, 2, 2
  v_bfe_u32 v58, v1, 1, 1
  v_lshrrev_b32 v59, 1, v57
  v_and_b32 v60, 1, v56
  v_lshl_or_b32 v59, v60, 1, v59
  v_lshlrev_b32 v59, 1, v59
  s_xor_b32 s48, s64, 1
  s_lshl_b32 s48, s48, 1
  v_or_b32 v60, s48, v58
  v_xor_b32 v60, v60, v59
  v_lshl_add_u32 v61, v56, 3, v57
  v_lshlrev_b32 v61, 7, v61
  v_lshl_add_u32 v61, v60, 4, v61
  v_and_b32 v60, 1, v1
  v_lshl_add_u32 v61, v60, 3, v61
  v_add_u32 v61, s66, v61
  v_mov_b32 v17, v61
  v_lshrrev_b32 v56, 4, v1
  v_bfe_u32 v57, v1, 2, 2
  v_bfe_u32 v58, v1, 1, 1
  v_lshrrev_b32 v59, 1, v57
  v_and_b32 v60, 1, v56
  v_lshl_or_b32 v59, v60, 1, v59
  v_lshlrev_b32 v59, 1, v59
  s_xor_b32 s48, s64, 2
  s_lshl_b32 s48, s48, 1
  v_or_b32 v60, s48, v58
  v_xor_b32 v60, v60, v59
  v_lshl_add_u32 v61, v56, 3, v57
  v_lshlrev_b32 v61, 7, v61
  v_lshl_add_u32 v61, v60, 4, v61
  v_and_b32 v60, 1, v1
  v_lshl_add_u32 v61, v60, 3, v61
  v_add_u32 v61, s66, v61
  v_mov_b32 v18, v61
  v_lshrrev_b32 v56, 4, v1
  v_bfe_u32 v57, v1, 2, 2
  v_bfe_u32 v58, v1, 1, 1
  v_lshrrev_b32 v59, 1, v57
  v_and_b32 v60, 1, v56
  v_lshl_or_b32 v59, v60, 1, v59
  v_lshlrev_b32 v59, 1, v59
  s_xor_b32 s48, s64, 3
  s_lshl_b32 s48, s48, 1
  v_or_b32 v60, s48, v58
  v_xor_b32 v60, v60, v59
  v_lshl_add_u32 v61, v56, 3, v57
  v_lshlrev_b32 v61, 7, v61
  v_lshl_add_u32 v61, v60, 4, v61
  v_and_b32 v60, 1, v1
  v_lshl_add_u32 v61, v60, 3, v61
  v_add_u32 v61, s66, v61
  v_mov_b32 v19, v61
  v_and_b32 v56, 15, v1
  v_lshrrev_b32 v57, 4, v1
  v_lshrrev_b32 v58, 1, v56
  s_lshl_b32 s66, s62, 6
  v_add_u32 v56, s66, v56
  v_lshlrev_b32 v56, 7, v56
  v_or_b32 v59, 0, v57
  v_xor_b32 v59, v59, v58
  v_lshl_add_u32 v59, v59, 4, v56
  s_xor_b32 s66, s63, 0
  s_lshl_b32 s66, s66, 11
  s_add_u32 s66, s66, 65536
  v_add_u32 v20, s66, v59
  s_xor_b32 s66, s63, 1
  s_lshl_b32 s66, s66, 11
  s_add_u32 s66, s66, 65536
  v_add_u32 v21, s66, v59
  s_xor_b32 s66, s63, 2
  s_lshl_b32 s66, s66, 11
  s_add_u32 s66, s66, 65536
  v_add_u32 v22, s66, v59
  s_xor_b32 s66, s63, 3
  s_lshl_b32 s66, s66, 11
  s_add_u32 s66, s66, 65536
  v_add_u32 v23, s66, v59
  v_or_b32 v59, 4, v57
  v_xor_b32 v59, v59, v58
  v_lshl_add_u32 v59, v59, 4, v56
  s_xor_b32 s66, s63, 0
  s_lshl_b32 s66, s66, 11
  s_add_u32 s66, s66, 65536
  v_add_u32 v24, s66, v59
  s_xor_b32 s66, s63, 1
  s_lshl_b32 s66, s66, 11
  s_add_u32 s66, s66, 65536
  v_add_u32 v25, s66, v59
  s_xor_b32 s66, s63, 2
  s_lshl_b32 s66, s66, 11
  s_add_u32 s66, s66, 65536
  v_add_u32 v26, s66, v59
  s_xor_b32 s66, s63, 3
  s_lshl_b32 s66, s66, 11
  s_add_u32 s66, s66, 65536
  v_add_u32 v27, s66, v59
  v_mov_b32 v31, 0
  s_lshl_b32 s74, s45, 7
  s_add_u32 s74, s74, 16842752
  s_lshl_b32 s75, s18, 7
  s_add_u32 s75, s75, 16844800
  v_mov_b32 v11, s74
  v_mov_b32 v8, s75
  v_and_b32 v9, 1, v1
  v_cmp_eq_u32 vcc, 1, v9
  s_nop 1
  v_cndmask_b32 v28, v11, v8, vcc
  v_mov_b32 v240, 0
  v_mov_b32 v241, 0
  v_mov_b32 v242, 0
  v_mov_b32 v243, 0
  v_mov_b32 v244, 0
  v_mov_b32 v245, 0
  v_mov_b32 v246, 0
  v_mov_b32 v247, 0
  v_mov_b32 v32, 0
  v_mov_b32 v33, 0
  v_mov_b32 v34, 0
  v_mov_b32 v35, 0
  v_mov_b32 v36, 0
  v_mov_b32 v37, 0
  v_mov_b32 v38, 0
  v_mov_b32 v39, 0
  v_mov_b32 v40, 0
  v_mov_b32 v41, 0
  v_mov_b32 v42, 0
  v_mov_b32 v43, 0
  v_mov_b32 v44, 0
  v_mov_b32 v45, 0
  v_mov_b32 v46, 0
  v_mov_b32 v47, 0
  v_mov_b32 v48, 0
  v_mov_b32 v49, 0
  v_mov_b32 v50, 0
  v_mov_b32 v51, 0
  v_mov_b32 v52, 0
  v_mov_b32 v53, 0
  v_mov_b32 v54, 0
  v_mov_b32 v55, 0
  v_mov_b32 v56, 0
  v_mov_b32 v57, 0
  v_mov_b32 v58, 0
  v_mov_b32 v59, 0
  v_mov_b32 v60, 0
  v_mov_b32 v61, 0
  v_mov_b32 v62, 0
  v_mov_b32 v63, 0
  v_mov_b32 v64, 0
  v_mov_b32 v65, 0
  v_mov_b32 v66, 0
  v_mov_b32 v67, 0
  v_mov_b32 v68, 0
  v_mov_b32 v69, 0
  v_mov_b32 v70, 0
  v_mov_b32 v71, 0
  v_mov_b32 v72, 0
  v_mov_b32 v73, 0
  v_mov_b32 v74, 0
  v_mov_b32 v75, 0
  v_mov_b32 v76, 0
  v_mov_b32 v77, 0
  v_mov_b32 v78, 0
  v_mov_b32 v79, 0
  v_mov_b32 v80, 0
  v_mov_b32 v81, 0
  v_mov_b32 v82, 0
  v_mov_b32 v83, 0
  v_mov_b32 v84, 0
  v_mov_b32 v85, 0
  v_mov_b32 v86, 0
  v_mov_b32 v87, 0
  v_mov_b32 v88, 0
  v_mov_b32 v89, 0
  v_mov_b32 v90, 0
  v_mov_b32 v91, 0
  v_mov_b32 v92, 0
  v_mov_b32 v93, 0
  v_mov_b32 v94, 0
  v_mov_b32 v95, 0
  v_mov_b32 v96, 0
  v_mov_b32 v97, 0
  v_mov_b32 v98, 0
  v_mov_b32 v99, 0
  v_mov_b32 v100, 0
  v_mov_b32 v101, 0
  v_mov_b32 v102, 0
  v_mov_b32 v103, 0
  v_mov_b32 v12, 0x3f803f80
  v_mov_b32 v13, 0x3f803f80
  v_mov_b32 v14, 0x3f803f80
  v_mov_b32 v15, 0x3f803f80
  s_waitcnt vmcnt(8)
  s_barrier
  ds_read_b64_tr_b16 v[104:105], v16 offset:0
  ds_read_b64_tr_b16 v[106:107], v16 offset:512
  ds_read_b64_tr_b16 v[108:109], v17 offset:0
  ds_read_b64_tr_b16 v[110:111], v17 offset:512
  ds_read_b64_tr_b16 v[112:113], v18 offset:0
  ds_read_b64_tr_b16 v[114:115], v18 offset:512
  ds_read_b64_tr_b16 v[116:117], v19 offset:0
  ds_read_b64_tr_b16 v[118:119], v19 offset:512
  ds_read_b128 v[136:139], v20 offset:0
  ds_read_b128 v[140:143], v21 offset:0
  ds_read_b128 v[144:147], v22 offset:0
  ds_read_b128 v[148:151], v23 offset:0
  ds_read_b128 v[152:155], v24 offset:0
  ds_read_b128 v[156:159], v25 offset:0
  ds_read_b128 v[160:163], v26 offset:0
  ds_read_b128 v[164:167], v27 offset:0
  s_cmp_ge_u32 s44, 4
  s_cbranch_scc1 K1_HQ_NOP2
  s_add_u32 m0, s53, 32768
  s_nop 0
  buffer_load_dwordx4 v248, s[24:27], s51 offen lds
  s_add_u32 m0, s54, 32768
  s_nop 0
  buffer_load_dwordx4 v249, s[24:27], s51 offen lds
  s_add_u32 m0, s36, 32768
  s_nop 0
  buffer_load_dwordx4 v250, s[24:27], s51 offen lds
  s_add_u32 m0, s37, 32768
  s_nop 0
  buffer_load_dwordx4 v251, s[24:27], s51 offen lds
  s_add_u32 s51, s51, s52
  s_add_u32 m0, s53, 49152
  s_nop 0
  buffer_load_dwordx4 v248, s[24:27], s51 offen lds
  s_add_u32 m0, s54, 49152
  s_nop 0
  buffer_load_dwordx4 v249, s[24:27], s51 offen lds
  s_add_u32 m0, s36, 49152
  s_nop 0
  buffer_load_dwordx4 v250, s[24:27], s51 offen lds
  s_add_u32 m0, s37, 49152
  s_nop 0
  buffer_load_dwordx4 v251, s[24:27], s51 offen lds
  s_add_u32 s51, s51, s52
  s_cmp_eq_u32 s51, s56
  s_cselect_b32 s51, 0, s51
K1_HQ_NOP2:
  s_waitcnt vmcnt(12) lgkmcnt(0)
  s_cmp_eq_u32 s68, 1
  s_cbranch_scc0 K1_NOZSIG
  s_waitcnt vmcnt(0)
  v_mov_b32 v10, 1
  v_mov_b32 v11, 0
  s_mov_b64 exec, 1
  buffer_atomic_add v10, v11, s[32:35], 0 offen
  s_mov_b64 exec, -1
K1_NOZSIG:
  s_mov_b32 s47, 6
  s_mov_b32 s49, 4
  s_cmp_ge_u32 s44, 4
  s_cselect_b32 s63, 8192, 0
  s_or_b32 s49, s49, s63
  s_cmp_eq_u32 s44, 7
  s_cselect_b32 s63, 4808, 0
  s_or_b32 s49, s49, s63
  s_cmp_lt_u32 s60, 740
  s_cselect_b32 s63, 64, 0
  s_or_b32 s49, s49, s63
  s_mov_b32 s19, 0
  s_mov_b64 vcc, 0
  s_cmp_ge_u32 s44, 4
  s_cbranch_scc1 K1_HQS_LOOP
K1_HQL_LOOP:
  s_barrier
  s_cbranch_vccnz K1_HQL_HK0
K1_HQL_HK0_B:
  v_mfma_f32_16x16x32_bf16 v[32:35], v[104:107], v[136:139], v[32:35]
  s_add_u32 m0, s55, 0
  s_nop 0
  buffer_load_dwordx4 v2, s[20:23], s50 offen lds
  s_add_u32 m0, s55, 1024
  s_nop 0
  buffer_load_dwordx4 v3, s[20:23], s50 offen lds
  v_mfma_f32_16x16x32_bf16 v[36:39], v[104:107], v[140:143], v[36:39]
  s_add_u32 m0, s55, 2048
  s_nop 0
  buffer_load_dwordx4 v4, s[20:23], s50 offen lds
  s_add_u32 m0, s55, 3072
  s_nop 0
  buffer_load_dwordx4 v5, s[20:23], s50 offen lds
  s_add_u32 s50, s50, 128
  v_mfma_f32_16x16x32_bf16 v[40:43], v[104:107], v[144:147], v[40:43]
  s_cmp_eq_u32 s50, 1280
  s_cselect_b32 s50, 0, s50
  s_add_u32 m0, s53, 0
  s_nop 0
  buffer_load_dwordx4 v248, s[24:27], s51 offen lds
  v_mfma_f32_16x16x32_bf16 v[44:47], v[104:107], v[148:151], v[44:47]
  s_add_u32 m0, s54, 0
  s_nop 0
  buffer_load_dwordx4 v249, s[24:27], s51 offen lds
  v_mfma_f32_16x16x32_bf16 v[48:51], v[108:111], v[136:139], v[48:51]
  s_add_u32 m0, s36, 0
  s_nop 0
  buffer_load_dwordx4 v250, s[24:27], s51 offen lds
  v_mfma_f32_16x16x32_bf16 v[52:55], v[108:111], v[140:143], v[52:55]
  s_add_u32 m0, s37, 0
  s_nop 0
  buffer_load_dwordx4 v251, s[24:27], s51 offen lds
  s_add_u32 s51, s51, s52
  v_mfma_f32_16x16x32_bf16 v[56:59], v[108:111], v[144:147], v[56:59]
  ds_read_b64_tr_b16 v[120:121], v16 offset:16384
  v_mfma_f32_16x16x32_bf16 v[60:63], v[108:111], v[148:151], v[60:63]
  ds_read_b64_tr_b16 v[122:123], v16 offset:16896
  v_mfma_f32_16x16x32_bf16 v[64:67], v[112:115], v[136:139], v[64:67]
  ds_read_b64_tr_b16 v[124:125], v17 offset:16384
  v_mfma_f32_16x16x32_bf16 v[68:71], v[112:115], v[140:143], v[68:71]
  ds_read_b64_tr_b16 v[126:127], v17 offset:16896
  v_mfma_f32_16x16x32_bf16 v[72:75], v[112:115], v[144:147], v[72:75]
  ds_read_b64_tr_b16 v[128:129], v18 offset:16384
  v_mfma_f32_16x16x32_bf16 v[76:79], v[112:115], v[148:151], v[76:79]
  ds_read_b64_tr_b16 v[130:131], v18 offset:16896
  v_mfma_f32_16x16x32_bf16 v[80:83], v[116:119], v[136:139], v[80:83]
  ds_read_b64_tr_b16 v[132:133], v19 offset:16384
  v_mfma_f32_16x16x32_bf16 v[84:87], v[116:119], v[140:143], v[84:87]
  ds_read_b64_tr_b16 v[134:135], v19 offset:16896
  v_mfma_f32_16x16x32_bf16 v[88:91], v[116:119], v[144:147], v[88:91]
  s_add_u32 s19, s19, 1
  s_lshr_b32 s62, s49, s19
  v_mfma_f32_16x16x32_bf16 v[92:95], v[116:119], v[148:151], v[92:95]
  s_and_b32 vcc_lo, s62, 1
  s_bitcmp1_b32 s47, s19
  s_cbranch_scc1 K1_HQL_XT0
K1_HQL_XT0_B:
  s_waitcnt vmcnt(12) lgkmcnt(0)
  s_barrier
  s_cbranch_vccnz K1_HQL_HK1
K1_HQL_HK1_B:
  v_mfma_f32_16x16x32_bf16 v[32:35], v[120:123], v[152:155], v[32:35]
  s_add_u32 m0, s53, 16384
  s_nop 0
  buffer_load_dwordx4 v248, s[24:27], s51 offen lds
  s_add_u32 m0, s54, 16384
  s_nop 0
  buffer_load_dwordx4 v249, s[24:27], s51 offen lds
  v_mfma_f32_16x16x32_bf16 v[36:39], v[120:123], v[156:159], v[36:39]
  s_add_u32 m0, s36, 16384
  s_nop 0
  buffer_load_dwordx4 v250, s[24:27], s51 offen lds
  s_add_u32 m0, s37, 16384
  s_nop 0
  buffer_load_dwordx4 v251, s[24:27], s51 offen lds
  s_add_u32 s51, s51, s52
  v_mfma_f32_16x16x32_bf16 v[40:43], v[120:123], v[160:163], v[40:43]
  s_cmp_eq_u32 s51, s56
  s_cselect_b32 s51, 0, s51
  ds_read_b64_tr_b16 v[104:105], v16 offset:32768
  v_mfma_f32_16x16x32_bf16 v[44:47], v[120:123], v[164:167], v[44:47]
  ds_read_b64_tr_b16 v[106:107], v16 offset:33280
  ds_read_b64_tr_b16 v[108:109], v17 offset:32768
  v_mfma_f32_16x16x32_bf16 v[48:51], v[124:127], v[152:155], v[48:51]
  ds_read_b64_tr_b16 v[110:111], v17 offset:33280
  ds_read_b64_tr_b16 v[112:113], v18 offset:32768
  v_mfma_f32_16x16x32_bf16 v[52:55], v[124:127], v[156:159], v[52:55]
  ds_read_b64_tr_b16 v[114:115], v18 offset:33280
  ds_read_b64_tr_b16 v[116:117], v19 offset:32768
  v_mfma_f32_16x16x32_bf16 v[56:59], v[124:127], v[160:163], v[56:59]
  ds_read_b64_tr_b16 v[118:119], v19 offset:33280
  ds_read_b128 v[168:171], v20 offset:16384
  v_mfma_f32_16x16x32_bf16 v[60:63], v[124:127], v[164:167], v[60:63]
  ds_read_b128 v[172:175], v21 offset:16384
  v_mfma_f32_16x16x32_bf16 v[64:67], v[128:131], v[152:155], v[64:67]
  ds_read_b128 v[176:179], v22 offset:16384
  v_mfma_f32_16x16x32_bf16 v[68:71], v[128:131], v[156:159], v[68:71]
  ds_read_b128 v[180:183], v23 offset:16384
  v_mfma_f32_16x16x32_bf16 v[72:75], v[128:131], v[160:163], v[72:75]
  ds_read_b128 v[184:187], v24 offset:16384
  v_mfma_f32_16x16x32_bf16 v[76:79], v[128:131], v[164:167], v[76:79]
  ds_read_b128 v[188:191], v25 offset:16384
  v_mfma_f32_16x16x32_bf16 v[80:83], v[132:135], v[152:155], v[80:83]
  ds_read_b128 v[192:195], v26 offset:16384
  v_mfma_f32_16x16x32_bf16 v[84:87], v[132:135], v[156:159], v[84:87]
  ds_read_b128 v[196:199], v27 offset:16384
  v_mfma_f32_16x16x32_bf16 v[88:91], v[132:135], v[160:163], v[88:91]
  s_add_u32 s19, s19, 1
  s_lshr_b32 s62, s49, s19
  v_mfma_f32_16x16x32_bf16 v[92:95], v[132:135], v[164:167], v[92:95]
  s_and_b32 vcc_lo, s62, 1
  s_bitcmp1_b32 s47, s19
  s_cbranch_scc1 K1_HQL_XT1
K1_HQL_XT1_B:
  s_waitcnt vmcnt(12) lgkmcnt(0)
  s_barrier
  s_cbranch_vccnz K1_HQL_HK2
K1_HQL_HK2_B:
  v_mfma_f32_16x16x32_bf16 v[32:35], v[104:107], v[168:171], v[32:35]
  s_add_u32 m0, s55, 16384
  s_nop 0
  buffer_load_dwordx4 v2, s[20:23], s50 offen lds
  s_add_u32 m0, s55, 17408
  s_nop 0
  buffer_load_dwordx4 v3, s[20:23], s50 offen lds
  v_mfma_f32_16x16x32_bf16 v[36:39], v[104:107], v[172:175], v[36:39]
  s_add_u32 m0, s55, 18432
  s_nop 0
  buffer_load_dwordx4 v4, s[20:23], s50 offen lds
  s_add_u32 m0, s55, 19456
  s_nop 0
  buffer_load_dwordx4 v5, s[20:23], s50 offen lds
  s_add_u32 s50, s50, 128
  v_mfma_f32_16x16x32_bf16 v[40:43], v[104:107], v[176:179], v[40:43]
  s_cmp_eq_u32 s50, 1280
  s_cselect_b32 s50, 0, s50
  s_add_u32 m0, s53, 32768
  s_nop 0
  buffer_load_dwordx4 v248, s[24:27], s51 offen lds
  v_mfma_f32_16x16x32_bf16 v[44:47], v[104:107], v[180:183], v[44:47]
  s_add_u32 m0, s54, 32768
  s_nop 0
  buffer_load_dwordx4 v249, s[24:27], s51 offen lds
  v_mfma_f32_16x16x32_bf16 v[48:51], v[108:111], v[168:171], v[48:51]
  s_add_u32 m0, s36, 32768
  s_nop 0
  buffer_load_dwordx4 v250, s[24:27], s51 offen lds
  v_mfma_f32_16x16x32_bf16 v[52:55], v[108:111], v[172:175], v[52:55]
  s_add_u32 m0, s37, 32768
  s_nop 0
  buffer_load_dwordx4 v251, s[24:27], s51 offen lds
  s_add_u32 s51, s51, s52
  v_mfma_f32_16x16x32_bf16 v[56:59], v[108:111], v[176:179], v[56:59]
  ds_read_b64_tr_b16 v[120:121], v16 offset:49152
  v_mfma_f32_16x16x32_bf16 v[60:63], v[108:111], v[180:183], v[60:63]
  ds_read_b64_tr_b16 v[122:123], v16 offset:49664
  v_mfma_f32_16x16x32_bf16 v[64:67], v[112:115], v[168:171], v[64:67]
  ds_read_b64_tr_b16 v[124:125], v17 offset:49152
  v_mfma_f32_16x16x32_bf16 v[68:71], v[112:115], v[172:175], v[68:71]
  ds_read_b64_tr_b16 v[126:127], v17 offset:49664
  v_mfma_f32_16x16x32_bf16 v[72:75], v[112:115], v[176:179], v[72:75]
  ds_read_b64_tr_b16 v[128:129], v18 offset:49152
  v_mfma_f32_16x16x32_bf16 v[76:79], v[112:115], v[180:183], v[76:79]
  ds_read_b64_tr_b16 v[130:131], v18 offset:49664
  v_mfma_f32_16x16x32_bf16 v[80:83], v[116:119], v[168:171], v[80:83]
  ds_read_b64_tr_b16 v[132:133], v19 offset:49152
  v_mfma_f32_16x16x32_bf16 v[84:87], v[116:119], v[172:175], v[84:87]
  ds_read_b64_tr_b16 v[134:135], v19 offset:49664
  v_mfma_f32_16x16x32_bf16 v[88:91], v[116:119], v[176:179], v[88:91]
  s_add_u32 s19, s19, 1
  s_lshr_b32 s62, s49, s19
  v_mfma_f32_16x16x32_bf16 v[92:95], v[116:119], v[180:183], v[92:95]
  s_and_b32 vcc_lo, s62, 1
  s_bitcmp1_b32 s47, s19
  s_cbranch_scc1 K1_HQL_XT2
K1_HQL_XT2_B:
  s_waitcnt vmcnt(12) lgkmcnt(0)
  s_barrier
  s_cbranch_vccnz K1_HQL_HK3
K1_HQL_HK3_B:
  v_mfma_f32_16x16x32_bf16 v[32:35], v[120:123], v[184:187], v[32:35]
  s_add_u32 m0, s53, 49152
  s_nop 0
  buffer_load_dwordx4 v248, s[24:27], s51 offen lds
  s_add_u32 m0, s54, 49152
  s_nop 0
  buffer_load_dwordx4 v249, s[24:27], s51 offen lds
  v_mfma_f32_16x16x32_bf16 v[36:39], v[120:123], v[188:191], v[36:39]
  s_add_u32 m0, s36, 49152
  s_nop 0
  buffer_load_dwordx4 v250, s[24:27], s51 offen lds
  s_add_u32 m0, s37, 49152
  s_nop 0
  buffer_load_dwordx4 v251, s[24:27], s51 offen lds
  s_add_u32 s51, s51, s52
  v_mfma_f32_16x16x32_bf16 v[40:43], v[120:123], v[192:195], v[40:43]
  s_cmp_eq_u32 s51, s56
  s_cselect_b32 s51, 0, s51
  ds_read_b64_tr_b16 v[104:105], v16 offset:0
  v_mfma_f32_16x16x32_bf16 v[44:47], v[120:123], v[196:199], v[44:47]
  ds_read_b64_tr_b16 v[106:107], v16 offset:512
  ds_read_b64_tr_b16 v[108:109], v17 offset:0
  v_mfma_f32_16x16x32_bf16 v[48:51], v[124:127], v[184:187], v[48:51]
  ds_read_b64_tr_b16 v[110:111], v17 offset:512
  ds_read_b64_tr_b16 v[112:113], v18 offset:0
  v_mfma_f32_16x16x32_bf16 v[52:55], v[124:127], v[188:191], v[52:55]
  ds_read_b64_tr_b16 v[114:115], v18 offset:512
  ds_read_b64_tr_b16 v[116:117], v19 offset:0
  v_mfma_f32_16x16x32_bf16 v[56:59], v[124:127], v[192:195], v[56:59]
  ds_read_b64_tr_b16 v[118:119], v19 offset:512
  ds_read_b128 v[136:139], v20 offset:0
  v_mfma_f32_16x16x32_bf16 v[60:63], v[124:127], v[196:199], v[60:63]
  ds_read_b128 v[140:143], v21 offset:0
  v_mfma_f32_16x16x32_bf16 v[64:67], v[128:131], v[184:187], v[64:67]
  ds_read_b128 v[144:147], v22 offset:0
  v_mfma_f32_16x16x32_bf16 v[68:71], v[128:131], v[188:191], v[68:71]
  ds_read_b128 v[148:151], v23 offset:0
  v_mfma_f32_16x16x32_bf16 v[72:75], v[128:131], v[192:195], v[72:75]
  ds_read_b128 v[152:155], v24 offset:0
  v_mfma_f32_16x16x32_bf16 v[76:79], v[128:131], v[196:199], v[76:79]
  ds_read_b128 v[156:159], v25 offset:0
  v_mfma_f32_16x16x32_bf16 v[80:83], v[132:135], v[184:187], v[80:83]
  ds_read_b128 v[160:163], v26 offset:0
  v_mfma_f32_16x16x32_bf16 v[84:87], v[132:135], v[188:191], v[84:87]
  ds_read_b128 v[164:167], v27 offset:0
  v_mfma_f32_16x16x32_bf16 v[88:91], v[132:135], v[192:195], v[88:91]
  s_add_u32 s19, s19, 1
  s_lshr_b32 s62, s49, s19
  v_mfma_f32_16x16x32_bf16 v[92:95], v[132:135], v[196:199], v[92:95]
  s_and_b32 vcc_lo, s62, 1
  s_bitcmp1_b32 s47, s19
  s_cbranch_scc1 K1_HQL_XT3
K1_HQL_XT3_B:
  s_waitcnt vmcnt(12) lgkmcnt(0)
  s_cmp_lt_u32 s19, 16
  s_cbranch_scc1 K1_HQL_LOOP
  s_barrier
  v_mfma_f32_16x16x32_bf16 v[32:35], v[104:107], v[136:139], v[32:35]
  ds_read_b64_tr_b16 v[120:121], v16 offset:16384
  v_mfma_f32_16x16x32_bf16 v[36:39], v[104:107], v[140:143], v[36:39]
  ds_read_b64_tr_b16 v[122:123], v16 offset:16896
  v_mfma_f32_16x16x32_bf16 v[40:43], v[104:107], v[144:147], v[40:43]
  ds_read_b64_tr_b16 v[124:125], v17 offset:16384
  v_mfma_f32_16x16x32_bf16 v[44:47], v[104:107], v[148:151], v[44:47]
  ds_read_b64_tr_b16 v[126:127], v17 offset:16896
  v_mfma_f32_16x16x32_bf16 v[48:51], v[108:111], v[136:139], v[48:51]
  ds_read_b64_tr_b16 v[128:129], v18 offset:16384
  v_mfma_f32_16x16x32_bf16 v[52:55], v[108:111], v[140:143], v[52:55]
  ds_read_b64_tr_b16 v[130:131], v18 offset:16896
  v_mfma_f32_16x16x32_bf16 v[56:59], v[108:111], v[144:147], v[56:59]
  ds_read_b64_tr_b16 v[132:133], v19 offset:16384
  v_mfma_f32_16x16x32_bf16 v[60:63], v[108:111], v[148:151], v[60:63]
  ds_read_b64_tr_b16 v[134:135], v19 offset:16896
  v_mfma_f32_16x16x32_bf16 v[64:67], v[112:115], v[136:139], v[64:67]
  v_mfma_f32_16x16x32_bf16 v[68:71], v[112:115], v[140:143], v[68:71]
  v_mfma_f32_16x16x32_bf16 v[72:75], v[112:115], v[144:147], v[72:75]
  v_mfma_f32_16x16x32_bf16 v[76:79], v[112:115], v[148:151], v[76:79]
  v_mfma_f32_16x16x32_bf16 v[80:83], v[116:119], v[136:139], v[80:83]
  v_mfma_f32_16x16x32_bf16 v[84:87], v[116:119], v[140:143], v[84:87]
  v_mfma_f32_16x16x32_bf16 v[88:91], v[116:119], v[144:147], v[88:91]
  v_mfma_f32_16x16x32_bf16 v[92:95], v[116:119], v[148:151], v[92:95]
  s_waitcnt vmcnt(4) lgkmcnt(0)
  s_barrier
  v_mfma_f32_16x16x32_bf16 v[32:35], v[120:123], v[152:155], v[32:35]
  ds_read_b64_tr_b16 v[104:105], v16 offset:32768
  v_mfma_f32_16x16x32_bf16 v[36:39], v[120:123], v[156:159], v[36:39]
  ds_read_b64_tr_b16 v[106:107], v16 offset:33280
  v_mfma_f32_16x16x32_bf16 v[40:43], v[120:123], v[160:163], v[40:43]
  ds_read_b64_tr_b16 v[108:109], v17 offset:32768
  v_mfma_f32_16x16x32_bf16 v[44:47], v[120:123], v[164:167], v[44:47]
  ds_read_b64_tr_b16 v[110:111], v17 offset:33280
  v_mfma_f32_16x16x32_bf16 v[48:51], v[124:127], v[152:155], v[48:51]
  ds_read_b64_tr_b16 v[112:113], v18 offset:32768
  v_mfma_f32_16x16x32_bf16 v[52:55], v[124:127], v[156:159], v[52:55]
  ds_read_b64_tr_b16 v[114:115], v18 offset:33280
  v_mfma_f32_16x16x32_bf16 v[56:59], v[124:127], v[160:163], v[56:59]
  ds_read_b64_tr_b16 v[116:117], v19 offset:32768
  v_mfma_f32_16x16x32_bf16 v[60:63], v[124:127], v[164:167], v[60:63]
  ds_read_b64_tr_b16 v[118:119], v19 offset:33280
  v_mfma_f32_16x16x32_bf16 v[64:67], v[128:131], v[152:155], v[64:67]
  ds_read_b128 v[168:171], v20 offset:16384
  v_mfma_f32_16x16x32_bf16 v[68:71], v[128:131], v[156:159], v[68:71]
  ds_read_b128 v[172:175], v21 offset:16384
  v_mfma_f32_16x16x32_bf16 v[72:75], v[128:131], v[160:163], v[72:75]
  ds_read_b128 v[176:179], v22 offset:16384
  v_mfma_f32_16x16x32_bf16 v[76:79], v[128:131], v[164:167], v[76:79]
  ds_read_b128 v[180:183], v23 offset:16384
  v_mfma_f32_16x16x32_bf16 v[80:83], v[132:135], v[152:155], v[80:83]
  ds_read_b128 v[184:187], v24 offset:16384
  v_mfma_f32_16x16x32_bf16 v[84:87], v[132:135], v[156:159], v[84:87]
  ds_read_b128 v[188:191], v25 offset:16384
  v_mfma_f32_16x16x32_bf16 v[88:91], v[132:135], v[160:163], v[88:91]
  ds_read_b128 v[192:195], v26 offset:16384
  v_mfma_f32_16x16x32_bf16 v[92:95], v[132:135], v[164:167], v[92:95]
  ds_read_b128 v[196:199], v27 offset:16384
  s_waitcnt vmcnt(0) lgkmcnt(0)
  s_barrier
  v_mfma_f32_16x16x32_bf16 v[32:35], v[104:107], v[168:171], v[32:35]
  ds_read_b64_tr_b16 v[120:121], v16 offset:49152
  v_mfma_f32_16x16x32_bf16 v[36:39], v[104:107], v[172:175], v[36:39]
  ds_read_b64_tr_b16 v[122:123], v16 offset:49664
  v_mfma_f32_16x16x32_bf16 v[40:43], v[104:107], v[176:179], v[40:43]
  ds_read_b64_tr_b16 v[124:125], v17 offset:49152
  v_mfma_f32_16x16x32_bf16 v[44:47], v[104:107], v[180:183], v[44:47]
  ds_read_b64_tr_b16 v[126:127], v17 offset:49664
  v_mfma_f32_16x16x32_bf16 v[48:51], v[108:111], v[168:171], v[48:51]
  ds_read_b64_tr_b16 v[128:129], v18 offset:49152
  v_mfma_f32_16x16x32_bf16 v[52:55], v[108:111], v[172:175], v[52:55]
  ds_read_b64_tr_b16 v[130:131], v18 offset:49664
  v_mfma_f32_16x16x32_bf16 v[56:59], v[108:111], v[176:179], v[56:59]
  ds_read_b64_tr_b16 v[132:133], v19 offset:49152
  v_mfma_f32_16x16x32_bf16 v[60:63], v[108:111], v[180:183], v[60:63]
  ds_read_b64_tr_b16 v[134:135], v19 offset:49664
  v_mfma_f32_16x16x32_bf16 v[64:67], v[112:115], v[168:171], v[64:67]
  v_mfma_f32_16x16x32_bf16 v[68:71], v[112:115], v[172:175], v[68:71]
  v_mfma_f32_16x16x32_bf16 v[72:75], v[112:115], v[176:179], v[72:75]
  v_mfma_f32_16x16x32_bf16 v[76:79], v[112:115], v[180:183], v[76:79]
  v_mfma_f32_16x16x32_bf16 v[80:83], v[116:119], v[168:171], v[80:83]
  v_mfma_f32_16x16x32_bf16 v[84:87], v[116:119], v[172:175], v[84:87]
  v_mfma_f32_16x16x32_bf16 v[88:91], v[116:119], v[176:179], v[88:91]
  v_mfma_f32_16x16x32_bf16 v[92:95], v[116:119], v[180:183], v[92:95]
  s_waitcnt lgkmcnt(0)
  s_barrier
  v_mfma_f32_16x16x32_bf16 v[32:35], v[120:123], v[184:187], v[32:35]
  v_mfma_f32_16x16x32_bf16 v[36:39], v[120:123], v[188:191], v[36:39]
  v_mfma_f32_16x16x32_bf16 v[40:43], v[120:123], v[192:195], v[40:43]
  v_mfma_f32_16x16x32_bf16 v[44:47], v[120:123], v[196:199], v[44:47]
  v_mfma_f32_16x16x32_bf16 v[48:51], v[124:127], v[184:187], v[48:51]
  v_mfma_f32_16x16x32_bf16 v[52:55], v[124:127], v[188:191], v[52:55]
  v_mfma_f32_16x16x32_bf16 v[56:59], v[124:127], v[192:195], v[56:59]
  v_mfma_f32_16x16x32_bf16 v[60:63], v[124:127], v[196:199], v[60:63]
  v_mfma_f32_16x16x32_bf16 v[64:67], v[128:131], v[184:187], v[64:67]
  v_mfma_f32_16x16x32_bf16 v[68:71], v[128:131], v[188:191], v[68:71]
  v_mfma_f32_16x16x32_bf16 v[72:75], v[128:131], v[192:195], v[72:75]
  v_mfma_f32_16x16x32_bf16 v[76:79], v[128:131], v[196:199], v[76:79]
  v_mfma_f32_16x16x32_bf16 v[80:83], v[132:135], v[184:187], v[80:83]
  v_mfma_f32_16x16x32_bf16 v[84:87], v[132:135], v[188:191], v[84:87]
  v_mfma_f32_16x16x32_bf16 v[88:91], v[132:135], v[192:195], v[88:91]
  v_mfma_f32_16x16x32_bf16 v[92:95], v[132:135], v[196:199], v[92:95]
  s_nop 0
  s_branch K1_HQ_EPI
K1_HQS_LOOP:
  s_barrier
  s_cbranch_vccnz K1_HQS_HK0
K1_HQS_HK0_B:
  v_mfma_f32_16x16x32_bf16 v[32:35], v[104:107], v[136:139], v[32:35]
  ds_read_b64_tr_b16 v[120:121], v16 offset:16384
  v_mfma_f32_16x16x32_bf16 v[36:39], v[104:107], v[140:143], v[36:39]
  ds_read_b64_tr_b16 v[122:123], v16 offset:16896
  v_mfma_f32_16x16x32_bf16 v[40:43], v[104:107], v[144:147], v[40:43]
  ds_read_b64_tr_b16 v[124:125], v17 offset:16384
  v_mfma_f32_16x16x32_bf16 v[44:47], v[104:107], v[148:151], v[44:47]
  ds_read_b64_tr_b16 v[126:127], v17 offset:16896
  v_mfma_f32_16x16x32_bf16 v[48:51], v[108:111], v[136:139], v[48:51]
  ds_read_b64_tr_b16 v[128:129], v18 offset:16384
  v_mfma_f32_16x16x32_bf16 v[52:55], v[108:111], v[140:143], v[52:55]
  ds_read_b64_tr_b16 v[130:131], v18 offset:16896
  v_mfma_f32_16x16x32_bf16 v[56:59], v[108:111], v[144:147], v[56:59]
  ds_read_b64_tr_b16 v[132:133], v19 offset:16384
  v_mfma_f32_16x16x32_bf16 v[60:63], v[108:111], v[148:151], v[60:63]
  ds_read_b64_tr_b16 v[134:135], v19 offset:16896
  v_mfma_f32_16x16x32_bf16 v[64:67], v[112:115], v[136:139], v[64:67]
  s_add_u32 s19, s19, 1
  s_lshr_b32 s62, s49, s19
  v_mfma_f32_16x16x32_bf16 v[68:71], v[112:115], v[140:143], v[68:71]
  s_and_b32 vcc_lo, s62, 1
  s_bitcmp1_b32 s47, s19
  v_mfma_f32_16x16x32_bf16 v[72:75], v[112:115], v[144:147], v[72:75]
  v_mfma_f32_16x16x32_bf16 v[76:79], v[112:115], v[148:151], v[76:79]
  v_mfma_f32_16x16x32_bf16 v[80:83], v[116:119], v[136:139], v[80:83]
  v_mfma_f32_16x16x32_bf16 v[84:87], v[116:119], v[140:143], v[84:87]
  v_mfma_f32_16x16x32_bf16 v[88:91], v[116:119], v[144:147], v[88:91]
  v_mfma_f32_16x16x32_bf16 v[92:95], v[116:119], v[148:151], v[92:95]
  s_cbranch_scc1 K1_HQS_XT0
K1_HQS_XT0_B:
  s_waitcnt lgkmcnt(0)
  s_barrier
  s_cbranch_vccnz K1_HQS_HK1
K1_HQS_HK1_B:
  v_mfma_f32_16x16x32_bf16 v[32:35], v[120:123], v[152:155], v[32:35]
  ds_read_b64_tr_b16 v[104:105], v16 offset:32768
  ds_read_b64_tr_b16 v[106:107], v16 offset:33280
  v_mfma_f32_16x16x32_bf16 v[36:39], v[120:123], v[156:159], v[36:39]
  ds_read_b64_tr_b16 v[108:109], v17 offset:32768
  ds_read_b64_tr_b16 v[110:111], v17 offset:33280
  v_mfma_f32_16x16x32_bf16 v[40:43], v[120:123], v[160:163], v[40:43]
  ds_read_b64_tr_b16 v[112:113], v18 offset:32768
  v_mfma_f32_16x16x32_bf16 v[44:47], v[120:123], v[164:167], v[44:47]
  ds_read_b64_tr_b16 v[114:115], v18 offset:33280
  v_mfma_f32_16x16x32_bf16 v[48:51], v[124:127], v[152:155], v[48:51]
  ds_read_b64_tr_b16 v[116:117], v19 offset:32768
  v_mfma_f32_16x16x32_bf16 v[52:55], v[124:127], v[156:159], v[52:55]
  ds_read_b64_tr_b16 v[118:119], v19 offset:33280
  v_mfma_f32_16x16x32_bf16 v[56:59], v[124:127], v[160:163], v[56:59]
  ds_read_b128 v[168:171], v20 offset:16384
  v_mfma_f32_16x16x32_bf16 v[60:63], v[124:127], v[164:167], v[60:63]
  ds_read_b128 v[172:175], v21 offset:16384
  v_mfma_f32_16x16x32_bf16 v[64:67], v[128:131], v[152:155], v[64:67]
  ds_read_b128 v[176:179], v22 offset:16384
  v_mfma_f32_16x16x32_bf16 v[68:71], v[128:131], v[156:159], v[68:71]
  ds_read_b128 v[180:183], v23 offset:16384
  v_mfma_f32_16x16x32_bf16 v[72:75], v[128:131], v[160:163], v[72:75]
  ds_read_b128 v[184:187], v24 offset:16384
  v_mfma_f32_16x16x32_bf16 v[76:79], v[128:131], v[164:167], v[76:79]
  ds_read_b128 v[188:191], v25 offset:16384
  v_mfma_f32_16x16x32_bf16 v[80:83], v[132:135], v[152:155], v[80:83]
  ds_read_b128 v[192:195], v26 offset:16384
  v_mfma_f32_16x16x32_bf16 v[84:87], v[132:135], v[156:159], v[84:87]
  ds_read_b128 v[196:199], v27 offset:16384
  v_mfma_f32_16x16x32_bf16 v[88:91], v[132:135], v[160:163], v[88:91]
  s_add_u32 s19, s19, 1
  s_lshr_b32 s62, s49, s19
  v_mfma_f32_16x16x32_bf16 v[92:95], v[132:135], v[164:167], v[92:95]
  s_and_b32 vcc_lo, s62, 1
  s_bitcmp1_b32 s47, s19
  s_cbranch_scc1 K1_HQS_XT1
K1_HQS_XT1_B:
  s_waitcnt lgkmcnt(0)
  s_barrier
  s_cbranch_vccnz K1_HQS_HK2
K1_HQS_HK2_B:
  v_mfma_f32_16x16x32_bf16 v[32:35], v[104:107], v[168:171], v[32:35]
  ds_read_b64_tr_b16 v[120:121], v16 offset:49152
  v_mfma_f32_16x16x32_bf16 v[36:39], v[104:107], v[172:175], v[36:39]
  ds_read_b64_tr_b16 v[122:123], v16 offset:49664
  v_mfma_f32_16x16x32_bf16 v[40:43], v[104:107], v[176:179], v[40:43]
  ds_read_b64_tr_b16 v[124:125], v17 offset:49152
  v_mfma_f32_16x16x32_bf16 v[44:47], v[104:107], v[180:183], v[44:47]
  ds_read_b64_tr_b16 v[126:127], v17 offset:49664
  v_mfma_f32_16x16x32_bf16 v[48:51], v[108:111], v[168:171], v[48:51]
  ds_read_b64_tr_b16 v[128:129], v18 offset:49152
  v_mfma_f32_16x16x32_bf16 v[52:55], v[108:111], v[172:175], v[52:55]
  ds_read_b64_tr_b16 v[130:131], v18 offset:49664
  v_mfma_f32_16x16x32_bf16 v[56:59], v[108:111], v[176:179], v[56:59]
  ds_read_b64_tr_b16 v[132:133], v19 offset:49152
  v_mfma_f32_16x16x32_bf16 v[60:63], v[108:111], v[180:183], v[60:63]
  ds_read_b64_tr_b16 v[134:135], v19 offset:49664
  v_mfma_f32_16x16x32_bf16 v[64:67], v[112:115], v[168:171], v[64:67]
  s_add_u32 s19, s19, 1
  s_lshr_b32 s62, s49, s19
  v_mfma_f32_16x16x32_bf16 v[68:71], v[112:115], v[172:175], v[68:71]
  s_and_b32 vcc_lo, s62, 1
  s_bitcmp1_b32 s47, s19
  v_mfma_f32_16x16x32_bf16 v[72:75], v[112:115], v[176:179], v[72:75]
  v_mfma_f32_16x16x32_bf16 v[76:79], v[112:115], v[180:183], v[76:79]
  v_mfma_f32_16x16x32_bf16 v[80:83], v[116:119], v[168:171], v[80:83]
  v_mfma_f32_16x16x32_bf16 v[84:87], v[116:119], v[172:175], v[84:87]
  v_mfma_f32_16x16x32_bf16 v[88:91], v[116:119], v[176:179], v[88:91]
  v_mfma_f32_16x16x32_bf16 v[92:95], v[116:119], v[180:183], v[92:95]
  s_cbranch_scc1 K1_HQS_XT2
K1_HQS_XT2_B:
  s_waitcnt lgkmcnt(0)
  s_barrier
  s_cbranch_vccnz K1_HQS_HK3
K1_HQS_HK3_B:
  v_mfma_f32_16x16x32_bf16 v[32:35], v[120:123], v[184:187], v[32:35]
  ds_read_b64_tr_b16 v[104:105], v16 offset:0
  ds_read_b64_tr_b16 v[106:107], v16 offset:512
  v_mfma_f32_16x16x32_bf16 v[36:39], v[120:123], v[188:191], v[36:39]
  ds_read_b64_tr_b16 v[108:109], v17 offset:0
  ds_read_b64_tr_b16 v[110:111], v17 offset:512
  v_mfma_f32_16x16x32_bf16 v[40:43], v[120:123], v[192:195], v[40:43]
  ds_read_b64_tr_b16 v[112:113], v18 offset:0
  v_mfma_f32_16x16x32_bf16 v[44:47], v[120:123], v[196:199], v[44:47]
  ds_read_b64_tr_b16 v[114:115], v18 offset:512
  v_mfma_f32_16x16x32_bf16 v[48:51], v[124:127], v[184:187], v[48:51]
  ds_read_b64_tr_b16 v[116:117], v19 offset:0
  v_mfma_f32_16x16x32_bf16 v[52:55], v[124:127], v[188:191], v[52:55]
  ds_read_b64_tr_b16 v[118:119], v19 offset:512
  v_mfma_f32_16x16x32_bf16 v[56:59], v[124:127], v[192:195], v[56:59]
  ds_read_b128 v[136:139], v20 offset:0
  v_mfma_f32_16x16x32_bf16 v[60:63], v[124:127], v[196:199], v[60:63]
  ds_read_b128 v[140:143], v21 offset:0
  v_mfma_f32_16x16x32_bf16 v[64:67], v[128:131], v[184:187], v[64:67]
  ds_read_b128 v[144:147], v22 offset:0
  v_mfma_f32_16x16x32_bf16 v[68:71], v[128:131], v[188:191], v[68:71]
  ds_read_b128 v[148:151], v23 offset:0
  v_mfma_f32_16x16x32_bf16 v[72:75], v[128:131], v[192:195], v[72:75]
  ds_read_b128 v[152:155], v24 offset:0
  v_mfma_f32_16x16x32_bf16 v[76:79], v[128:131], v[196:199], v[76:79]
  ds_read_b128 v[156:159], v25 offset:0
  v_mfma_f32_16x16x32_bf16 v[80:83], v[132:135], v[184:187], v[80:83]
  ds_read_b128 v[160:163], v26 offset:0
  v_mfma_f32_16x16x32_bf16 v[84:87], v[132:135], v[188:191], v[84:87]
  ds_read_b128 v[164:167], v27 offset:0
  v_mfma_f32_16x16x32_bf16 v[88:91], v[132:135], v[192:195], v[88:91]
  s_add_u32 s19, s19, 1
  s_lshr_b32 s62, s49, s19
  v_mfma_f32_16x16x32_bf16 v[92:95], v[132:135], v[196:199], v[92:95]
  s_and_b32 vcc_lo, s62, 1
  s_bitcmp1_b32 s47, s19
  s_cbranch_scc1 K1_HQS_XT3
K1_HQS_XT3_B:
  s_waitcnt lgkmcnt(0)
  s_cmp_lt_u32 s19, 16
  s_cbranch_scc1 K1_HQS_LOOP
  s_barrier
  s_waitcnt vmcnt(0)
  v_add_f32 v200, v200, v210
  v_add_f32 v201, v201, v211
  v_add_f32 v202, v202, v212
  v_add_f32 v203, v203, v213
  v_add_f32 v204, v204, v214
  v_add_f32 v205, v205, v215
  v_add_f32 v206, v206, v216
  v_add_f32 v207, v207, v217
  v_add_f32 v208, v208, v218
  v_add_f32 v209, v209, v219
  v_add_f32 v200, v200, v202
  v_add_f32 v201, v201, v203
  v_add_f32 v204, v204, v206
  v_add_f32 v205, v205, v207
  v_add_f32 v200, v200, v208
  v_add_f32 v201, v201, v209
  v_add_f32 v200, v200, v204
  v_add_f32 v201, v201, v205
  s_and_b32 s62, s44, 1
  s_lshl_b32 s62, s62, 6
  v_add_u32 v11, s62, v1
  s_cmp_ge_u32 s44, 6
  s_cbranch_scc1 K1_HQS_FCS
  v_mul_f32 v200, 0x3acccccd, v200
  v_mul_f32 v9, 0x3acccccd, v201
  v_lshlrev_b32 v11, 2, v11
  v_fma_f32 v9, -v200, v200, v9
  v_add_u32 v11, 110592, v11
  v_max_f32 v9, 0, v9
  v_cvt_pk_bf16_f32 v10, v200, v9
  v_lshlrev_b32 v8, 16, v10
  v_and_b32 v9, 0xffff0000, v10
  v_add_f32 v9, 0x3727c5ac, v9
  v_sub_f32 v8, 0, v8
  v_cvt_pk_bf16_f32 v10, v9, v9
  v_lshlrev_b32 v9, 16, v10
  v_sqrt_f32 v9, v9
  s_nop 0
  v_cvt_pk_bf16_f32 v10, v9, v9
  v_lshlrev_b32 v9, 16, v10
  v_rcp_f32 v9, v9
  ds_write_b32 v11, v8
  ds_write_b32 v11, v9 offset:512
  s_branch K1_HQS_FDONE
K1_HQS_FCS:
  v_lshlrev_b32 v11, 3, v11
  v_add_u32 v11, 111616, v11
  ds_write_b64 v11, v[200:201]
K1_HQS_FDONE:
  v_mfma_f32_16x16x32_bf16 v[32:35], v[104:107], v[136:139], v[32:35]
  ds_read_b64_tr_b16 v[120:121], v16 offset:16384
  v_mfma_f32_16x16x32_bf16 v[36:39], v[104:107], v[140:143], v[36:39]
  ds_read_b64_tr_b16 v[122:123], v16 offset:16896
  v_mfma_f32_16x16x32_bf16 v[40:43], v[104:107], v[144:147], v[40:43]
  ds_read_b64_tr_b16 v[124:125], v17 offset:16384
  v_mfma_f32_16x16x32_bf16 v[44:47], v[104:107], v[148:151], v[44:47]
  ds_read_b64_tr_b16 v[126:127], v17 offset:16896
  v_mfma_f32_16x16x32_bf16 v[48:51], v[108:111], v[136:139], v[48:51]
  ds_read_b64_tr_b16 v[128:129], v18 offset:16384
  v_mfma_f32_16x16x32_bf16 v[52:55], v[108:111], v[140:143], v[52:55]
  ds_read_b64_tr_b16 v[130:131], v18 offset:16896
  v_mfma_f32_16x16x32_bf16 v[56:59], v[108:111], v[144:147], v[56:59]
  ds_read_b64_tr_b16 v[132:133], v19 offset:16384
  v_mfma_f32_16x16x32_bf16 v[60:63], v[108:111], v[148:151], v[60:63]
  ds_read_b64_tr_b16 v[134:135], v19 offset:16896
  v_mfma_f32_16x16x32_bf16 v[64:67], v[112:115], v[136:139], v[64:67]
  v_mfma_f32_16x16x32_bf16 v[68:71], v[112:115], v[140:143], v[68:71]
  v_mfma_f32_16x16x32_bf16 v[72:75], v[112:115], v[144:147], v[72:75]
  v_mfma_f32_16x16x32_bf16 v[76:79], v[112:115], v[148:151], v[76:79]
  v_mfma_f32_16x16x32_bf16 v[80:83], v[116:119], v[136:139], v[80:83]
  v_mfma_f32_16x16x32_bf16 v[84:87], v[116:119], v[140:143], v[84:87]
  v_mfma_f32_16x16x32_bf16 v[88:91], v[116:119], v[144:147], v[88:91]
  v_mfma_f32_16x16x32_bf16 v[92:95], v[116:119], v[148:151], v[92:95]
  s_waitcnt lgkmcnt(0)
  s_barrier
  v_mfma_f32_16x16x32_bf16 v[32:35], v[120:123], v[152:155], v[32:35]
  ds_read_b64_tr_b16 v[104:105], v16 offset:32768
  v_mfma_f32_16x16x32_bf16 v[36:39], v[120:123], v[156:159], v[36:39]
  ds_read_b64_tr_b16 v[106:107], v16 offset:33280
  v_mfma_f32_16x16x32_bf16 v[40:43], v[120:123], v[160:163], v[40:43]
  ds_read_b64_tr_b16 v[108:109], v17 offset:32768
  v_mfma_f32_16x16x32_bf16 v[44:47], v[120:123], v[164:167], v[44:47]
  ds_read_b64_tr_b16 v[110:111], v17 offset:33280
  v_mfma_f32_16x16x32_bf16 v[48:51], v[124:127], v[152:155], v[48:51]
  ds_read_b64_tr_b16 v[112:113], v18 offset:32768
  v_mfma_f32_16x16x32_bf16 v[52:55], v[124:127], v[156:159], v[52:55]
  ds_read_b64_tr_b16 v[114:115], v18 offset:33280
  v_mfma_f32_16x16x32_bf16 v[56:59], v[124:127], v[160:163], v[56:59]
  ds_read_b64_tr_b16 v[116:117], v19 offset:32768
  v_mfma_f32_16x16x32_bf16 v[60:63], v[124:127], v[164:167], v[60:63]
  ds_read_b64_tr_b16 v[118:119], v19 offset:33280
  v_mfma_f32_16x16x32_bf16 v[64:67], v[128:131], v[152:155], v[64:67]
  ds_read_b128 v[168:171], v20 offset:16384
  v_mfma_f32_16x16x32_bf16 v[68:71], v[128:131], v[156:159], v[68:71]
  ds_read_b128 v[172:175], v21 offset:16384
  v_mfma_f32_16x16x32_bf16 v[72:75], v[128:131], v[160:163], v[72:75]
  ds_read_b128 v[176:179], v22 offset:16384
  v_mfma_f32_16x16x32_bf16 v[76:79], v[128:131], v[164:167], v[76:79]
  ds_read_b128 v[180:183], v23 offset:16384
  v_mfma_f32_16x16x32_bf16 v[80:83], v[132:135], v[152:155], v[80:83]
  ds_read_b128 v[184:187], v24 offset:16384
  v_mfma_f32_16x16x32_bf16 v[84:87], v[132:135], v[156:159], v[84:87]
  ds_read_b128 v[188:191], v25 offset:16384
  v_mfma_f32_16x16x32_bf16 v[88:91], v[132:135], v[160:163], v[88:91]
  ds_read_b128 v[192:195], v26 offset:16384
  v_mfma_f32_16x16x32_bf16 v[92:95], v[132:135], v[164:167], v[92:95]
  ds_read_b128 v[196:199], v27 offset:16384
  s_waitcnt lgkmcnt(0)
  s_barrier
  s_cmp_eq_u32 s44, 7
  s_cbranch_scc0 K1_HQS_GDONE
  s_waitcnt vmcnt(0)
  s_mov_b32 s63, 2097152
K1_HQS_GALL_W:
  v_cmp_eq_u32 vcc, 16, v220
  s_sub_u32 s63, s63, 1
  s_cmp_eq_u32 s63, 0
  s_cbranch_scc1 K1_HQS_GDONE
  s_nop 0
  s_cmp_eq_u64 vcc, -1
  s_cbranch_scc1 K1_HQS_GDONE
  s_sleep 4
  v_and_b32 v10, 15, v1
  v_lshlrev_b32 v10, 7, v10
  s_mov_b32 s62, 16857088
  buffer_load_dword v220, v10, s[28:31], s62 offen sc1
  s_waitcnt vmcnt(0)
  s_branch K1_HQS_GALL_W
K1_HQS_GDONE:
  v_mfma_f32_16x16x32_bf16 v[32:35], v[104:107], v[168:171], v[32:35]
  ds_read_b64_tr_b16 v[120:121], v16 offset:49152
  v_mfma_f32_16x16x32_bf16 v[36:39], v[104:107], v[172:175], v[36:39]
  ds_read_b64_tr_b16 v[122:123], v16 offset:49664
  v_mfma_f32_16x16x32_bf16 v[40:43], v[104:107], v[176:179], v[40:43]
  ds_read_b64_tr_b16 v[124:125], v17 offset:49152
  v_mfma_f32_16x16x32_bf16 v[44:47], v[104:107], v[180:183], v[44:47]
  ds_read_b64_tr_b16 v[126:127], v17 offset:49664
  v_mfma_f32_16x16x32_bf16 v[48:51], v[108:111], v[168:171], v[48:51]
  ds_read_b64_tr_b16 v[128:129], v18 offset:49152
  v_mfma_f32_16x16x32_bf16 v[52:55], v[108:111], v[172:175], v[52:55]
  ds_read_b64_tr_b16 v[130:131], v18 offset:49664
  v_mfma_f32_16x16x32_bf16 v[56:59], v[108:111], v[176:179], v[56:59]
  ds_read_b64_tr_b16 v[132:133], v19 offset:49152
  v_mfma_f32_16x16x32_bf16 v[60:63], v[108:111], v[180:183], v[60:63]
  ds_read_b64_tr_b16 v[134:135], v19 offset:49664
  v_mfma_f32_16x16x32_bf16 v[64:67], v[112:115], v[168:171], v[64:67]
  v_mfma_f32_16x16x32_bf16 v[68:71], v[112:115], v[172:175], v[68:71]
  v_mfma_f32_16x16x32_bf16 v[72:75], v[112:115], v[176:179], v[72:75]
  v_mfma_f32_16x16x32_bf16 v[76:79], v[112:115], v[180:183], v[76:79]
  v_mfma_f32_16x16x32_bf16 v[80:83], v[116:119], v[168:171], v[80:83]
  v_mfma_f32_16x16x32_bf16 v[84:87], v[116:119], v[172:175], v[84:87]
  v_mfma_f32_16x16x32_bf16 v[88:91], v[116:119], v[176:179], v[88:91]
  v_mfma_f32_16x16x32_bf16 v[92:95], v[116:119], v[180:183], v[92:95]
  s_waitcnt lgkmcnt(0)
  s_barrier
  v_mfma_f32_16x16x32_bf16 v[32:35], v[120:123], v[184:187], v[32:35]
  v_mfma_f32_16x16x32_bf16 v[36:39], v[120:123], v[188:191], v[36:39]
  v_mfma_f32_16x16x32_bf16 v[40:43], v[120:123], v[192:195], v[40:43]
  v_mfma_f32_16x16x32_bf16 v[44:47], v[120:123], v[196:199], v[44:47]
  v_mfma_f32_16x16x32_bf16 v[48:51], v[124:127], v[184:187], v[48:51]
  v_mfma_f32_16x16x32_bf16 v[52:55], v[124:127], v[188:191], v[52:55]
  v_mfma_f32_16x16x32_bf16 v[56:59], v[124:127], v[192:195], v[56:59]
  v_mfma_f32_16x16x32_bf16 v[60:63], v[124:127], v[196:199], v[60:63]
  v_mfma_f32_16x16x32_bf16 v[64:67], v[128:131], v[184:187], v[64:67]
  v_mfma_f32_16x16x32_bf16 v[68:71], v[128:131], v[188:191], v[68:71]
  v_mfma_f32_16x16x32_bf16 v[72:75], v[128:131], v[192:195], v[72:75]
  v_mfma_f32_16x16x32_bf16 v[76:79], v[128:131], v[196:199], v[76:79]
  v_mfma_f32_16x16x32_bf16 v[80:83], v[132:135], v[184:187], v[80:83]
  v_mfma_f32_16x16x32_bf16 v[84:87], v[132:135], v[188:191], v[84:87]
  v_mfma_f32_16x16x32_bf16 v[88:91], v[132:135], v[192:195], v[88:91]
  v_mfma_f32_16x16x32_bf16 v[92:95], v[132:135], v[196:199], v[92:95]
  s_nop 0
K1_HQ_EPI:
  s_barrier
  s_and_b32 s70, s44, 1
  s_lshr_b32 s71, s44, 1
  s_lshl_b32 s72, s70, 6
  v_lshrrev_b32 v16, 4, v1
  v_lshlrev_b32 v17, 4, v16
  s_lshl_b32 s73, s71, 8
  s_add_u32 s73, s73, 111616
  s_lshl_b32 s74, s70, 1
  s_xor_b32 s75, s74, 0
  s_lshl_b32 s75, s75, 6
  s_add_u32 s75, s75, s73
  v_add_u32 v18, s75, v17
  s_xor_b32 s75, s74, 1
  s_lshl_b32 s75, s75, 6
  s_add_u32 s75, s75, s73
  v_add_u32 v19, s75, v17
  s_xor_b32 s75, s74, 2
  s_lshl_b32 s75, s75, 6
  s_add_u32 s75, s75, s73
  v_add_u32 v20, s75, v17
  s_xor_b32 s75, s74, 3
  s_lshl_b32 s75, s75, 6
  s_add_u32 s75, s75, s73
  v_add_u32 v21, s75, v17
  ds_read_b128 v[104:107], v18
  ds_read_b128 v[108:111], v19
  ds_read_b128 v[112:115], v20
  ds_read_b128 v[116:119], v21
  v_and_b32 v16, 15, v1
  v_add_u32 v16, s72, v16
  v_lshlrev_b32 v16, 2, v16
  s_xor_b32 s75, s71, 0
  s_lshl_b32 s75, s75, 6
  s_add_u32 s75, s75, 110592
  v_add_u32 v17, s75, v16
  ds_read2_b32 v[120:121], v17 offset1:128
  s_xor_b32 s75, s71, 1
  s_lshl_b32 s75, s75, 6
  s_add_u32 s75, s75, 110592
  v_add_u32 v17, s75, v16
  ds_read2_b32 v[122:123], v17 offset1:128
  s_xor_b32 s75, s71, 2
  s_lshl_b32 s75, s75, 6
  s_add_u32 s75, s75, 110592
  v_add_u32 v17, s75, v16
  ds_read2_b32 v[124:125], v17 offset1:128
  s_xor_b32 s75, s71, 3
  s_lshl_b32 s75, s75, 6
  s_add_u32 s75, s75, 110592
  v_add_u32 v17, s75, v16
  ds_read2_b32 v[126:127], v17 offset1:128
  s_lshl_b32 s61, s45, 1
  s_add_u32 s61, s61, s70
  v_lshlrev_b32 v16, 4, v1
  s_waitcnt lgkmcnt(0)
  s_cmp_eq_u32 s59, 1
  s_cbranch_scc1 K1_HQ_END
  v_mul_f32 v128, 0x3fb8aa3b, v121
  v_mul_f32 v129, 0.5, v121
  v_mul_f32 v130, 0x3fb8aa3b, v123
  v_mul_f32 v131, 0.5, v123
  v_mul_f32 v132, 0x3fb8aa3b, v125
  v_mul_f32 v133, 0.5, v125
  v_mul_f32 v134, 0x3fb8aa3b, v127
  v_mul_f32 v135, 0.5, v127
  s_cmp_eq_u32 s58, 1
  s_cbranch_scc1 K1_HQ_Q
  s_xor_b32 s72, s70, 0
  s_lshl_b32 s73, s57, 1
  s_add_u32 s72, s72, s73
  s_mov_b32 s73, s72
  s_cmp_ge_u32 s72, 14
  s_cselect_b32 s67, 5, 0
  s_add_u32 s73, s73, s67
  s_cmp_ge_u32 s72, 28
  s_cselect_b32 s67, 5, 0
  s_add_u32 s73, s73, s67
  s_cmp_ge_u32 s72, 41
  s_cselect_b32 s67, 5, 0
  s_add_u32 s73, s73, s67
  s_mul_i32 s74, s61, 74
  s_add_u32 s73, s73, s74
  s_lshl_b32 s73, s73, 12
  v_fmac_f32 v32, v104, v120
  v_fmac_f32 v33, v105, v120
  v_fmac_f32 v34, v106, v120
  v_fmac_f32 v35, v107, v120
  v_fmac_f32 v48, v108, v120
  v_fmac_f32 v49, v109, v120
  v_fmac_f32 v50, v110, v120
  v_fmac_f32 v51, v111, v120
  v_add_f32_e64 v32, v32, |v32|
  v_add_f32_e64 v33, v33, |v33|
  v_add_f32_e64 v34, v34, |v34|
  v_add_f32_e64 v35, v35, |v35|
  v_add_f32_e64 v48, v48, |v48|
  v_add_f32_e64 v49, v49, |v49|
  v_add_f32_e64 v50, v50, |v50|
  v_add_f32_e64 v51, v51, |v51|
  v_mul_f32 v32, v32, v129
  v_mul_f32 v33, v33, v129
  v_mul_f32 v34, v34, v129
  v_mul_f32 v35, v35, v129
  v_mul_f32 v48, v48, v129
  v_mul_f32 v49, v49, v129
  v_mul_f32 v50, v50, v129
  v_mul_f32 v51, v51, v129
  v_cvt_pk_bf16_f32 v136, v32, v33
  v_cvt_pk_bf16_f32 v137, v34, v35
  v_cvt_pk_bf16_f32 v138, v48, v49
  v_cvt_pk_bf16_f32 v139, v50, v51
  s_xor_b32 s75, s71, 0
  s_lshl_b32 s75, s75, 10
  s_add_u32 s75, s75, s73
  buffer_store_dwordx4 v[136:139], v16, s[28:31], s75 offen sc1
  v_fmac_f32 v36, v104, v122
  v_fmac_f32 v37, v105, v122
  v_fmac_f32 v38, v106, v122
  v_fmac_f32 v39, v107, v122
  v_fmac_f32 v52, v108, v122
  v_fmac_f32 v53, v109, v122
  v_fmac_f32 v54, v110, v122
  v_fmac_f32 v55, v111, v122
  v_add_f32_e64 v36, v36, |v36|
  v_add_f32_e64 v37, v37, |v37|
  v_add_f32_e64 v38, v38, |v38|
  v_add_f32_e64 v39, v39, |v39|
  v_add_f32_e64 v52, v52, |v52|
  v_add_f32_e64 v53, v53, |v53|
  v_add_f32_e64 v54, v54, |v54|
  v_add_f32_e64 v55, v55, |v55|
  v_mul_f32 v36, v36, v131
  v_mul_f32 v37, v37, v131
  v_mul_f32 v38, v38, v131
  v_mul_f32 v39, v39, v131
  v_mul_f32 v52, v52, v131
  v_mul_f32 v53, v53, v131
  v_mul_f32 v54, v54, v131
  v_mul_f32 v55, v55, v131
  v_cvt_pk_bf16_f32 v140, v36, v37
  v_cvt_pk_bf16_f32 v141, v38, v39
  v_cvt_pk_bf16_f32 v142, v52, v53
  v_cvt_pk_bf16_f32 v143, v54, v55
  s_xor_b32 s75, s71, 1
  s_lshl_b32 s75, s75, 10
  s_add_u32 s75, s75, s73
  buffer_store_dwordx4 v[140:143], v16, s[28:31], s75 offen sc1
  v_fmac_f32 v40, v104, v124
  v_fmac_f32 v41, v105, v124
  v_fmac_f32 v42, v106, v124
  v_fmac_f32 v43, v107, v124
  v_fmac_f32 v56, v108, v124
  v_fmac_f32 v57, v109, v124
  v_fmac_f32 v58, v110, v124
  v_fmac_f32 v59, v111, v124
  v_add_f32_e64 v40, v40, |v40|
  v_add_f32_e64 v41, v41, |v41|
  v_add_f32_e64 v42, v42, |v42|
  v_add_f32_e64 v43, v43, |v43|
  v_add_f32_e64 v56, v56, |v56|
  v_add_f32_e64 v57, v57, |v57|
  v_add_f32_e64 v58, v58, |v58|
  v_add_f32_e64 v59, v59, |v59|
  v_mul_f32 v40, v40, v133
  v_mul_f32 v41, v41, v133
  v_mul_f32 v42, v42, v133
  v_mul_f32 v43, v43, v133
  v_mul_f32 v56, v56, v133
  v_mul_f32 v57, v57, v133
  v_mul_f32 v58, v58, v133
  v_mul_f32 v59, v59, v133
  v_cvt_pk_bf16_f32 v144, v40, v41
  v_cvt_pk_bf16_f32 v145, v42, v43
  v_cvt_pk_bf16_f32 v146, v56, v57
  v_cvt_pk_bf16_f32 v147, v58, v59
  s_xor_b32 s75, s71, 2
  s_lshl_b32 s75, s75, 10
  s_add_u32 s75, s75, s73
  buffer_store_dwordx4 v[144:147], v16, s[28:31], s75 offen sc1
  v_fmac_f32 v44, v104, v126
  v_fmac_f32 v45, v105, v126
  v_fmac_f32 v46, v106, v126
  v_fmac_f32 v47, v107, v126
  v_fmac_f32 v60, v108, v126
  v_fmac_f32 v61, v109, v126
  v_fmac_f32 v62, v110, v126
  v_fmac_f32 v63, v111, v126
  v_add_f32_e64 v44, v44, |v44|
  v_add_f32_e64 v45, v45, |v45|
  v_add_f32_e64 v46, v46, |v46|
  v_add_f32_e64 v47, v47, |v47|
  v_add_f32_e64 v60, v60, |v60|
  v_add_f32_e64 v61, v61, |v61|
  v_add_f32_e64 v62, v62, |v62|
  v_add_f32_e64 v63, v63, |v63|
  v_mul_f32 v44, v44, v135
  v_mul_f32 v45, v45, v135
  v_mul_f32 v46, v46, v135
  v_mul_f32 v47, v47, v135
  v_mul_f32 v60, v60, v135
  v_mul_f32 v61, v61, v135
  v_mul_f32 v62, v62, v135
  v_mul_f32 v63, v63, v135
  v_cvt_pk_bf16_f32 v148, v44, v45
  v_cvt_pk_bf16_f32 v149, v46, v47
  v_cvt_pk_bf16_f32 v150, v60, v61
  v_cvt_pk_bf16_f32 v151, v62, v63
  s_xor_b32 s75, s71, 3
  s_lshl_b32 s75, s75, 10
  s_add_u32 s75, s75, s73
  buffer_store_dwordx4 v[148:151], v16, s[28:31], s75 offen sc1
  s_xor_b32 s72, s70, 1
  s_lshl_b32 s73, s57, 1
  s_add_u32 s72, s72, s73
  s_mov_b32 s73, s72
  s_cmp_ge_u32 s72, 14
  s_cselect_b32 s67, 5, 0
  s_add_u32 s73, s73, s67
  s_cmp_ge_u32 s72, 28
  s_cselect_b32 s67, 5, 0
  s_add_u32 s73, s73, s67
  s_cmp_ge_u32 s72, 41
  s_cselect_b32 s67, 5, 0
  s_add_u32 s73, s73, s67
  s_mul_i32 s74, s61, 74
  s_add_u32 s73, s73, s74
  s_lshl_b32 s73, s73, 12
  v_fmac_f32 v64, v112, v120
  v_fmac_f32 v65, v113, v120
  v_fmac_f32 v66, v114, v120
  v_fmac_f32 v67, v115, v120
  v_fmac_f32 v80, v116, v120
  v_fmac_f32 v81, v117, v120
  v_fmac_f32 v82, v118, v120
  v_fmac_f32 v83, v119, v120
  v_add_f32_e64 v64, v64, |v64|
  v_add_f32_e64 v65, v65, |v65|
  v_add_f32_e64 v66, v66, |v66|
  v_add_f32_e64 v67, v67, |v67|
  v_add_f32_e64 v80, v80, |v80|
  v_add_f32_e64 v81, v81, |v81|
  v_add_f32_e64 v82, v82, |v82|
  v_add_f32_e64 v83, v83, |v83|
  v_mul_f32 v64, v64, v129
  v_mul_f32 v65, v65, v129
  v_mul_f32 v66, v66, v129
  v_mul_f32 v67, v67, v129
  v_mul_f32 v80, v80, v129
  v_mul_f32 v81, v81, v129
  v_mul_f32 v82, v82, v129
  v_mul_f32 v83, v83, v129
  v_cvt_pk_bf16_f32 v152, v64, v65
  v_cvt_pk_bf16_f32 v153, v66, v67
  v_cvt_pk_bf16_f32 v154, v80, v81
  v_cvt_pk_bf16_f32 v155, v82, v83
  s_xor_b32 s75, s71, 0
  s_lshl_b32 s75, s75, 10
  s_add_u32 s75, s75, s73
  buffer_store_dwordx4 v[152:155], v16, s[28:31], s75 offen sc1
  v_fmac_f32 v68, v112, v122
  v_fmac_f32 v69, v113, v122
  v_fmac_f32 v70, v114, v122
  v_fmac_f32 v71, v115, v122
  v_fmac_f32 v84, v116, v122
  v_fmac_f32 v85, v117, v122
  v_fmac_f32 v86, v118, v122
  v_fmac_f32 v87, v119, v122
  v_add_f32_e64 v68, v68, |v68|
  v_add_f32_e64 v69, v69, |v69|
  v_add_f32_e64 v70, v70, |v70|
  v_add_f32_e64 v71, v71, |v71|
  v_add_f32_e64 v84, v84, |v84|
  v_add_f32_e64 v85, v85, |v85|
  v_add_f32_e64 v86, v86, |v86|
  v_add_f32_e64 v87, v87, |v87|
  v_mul_f32 v68, v68, v131
  v_mul_f32 v69, v69, v131
  v_mul_f32 v70, v70, v131
  v_mul_f32 v71, v71, v131
  v_mul_f32 v84, v84, v131
  v_mul_f32 v85, v85, v131
  v_mul_f32 v86, v86, v131
  v_mul_f32 v87, v87, v131
  v_cvt_pk_bf16_f32 v156, v68, v69
  v_cvt_pk_bf16_f32 v157, v70, v71
  v_cvt_pk_bf16_f32 v158, v84, v85
  v_cvt_pk_bf16_f32 v159, v86, v87
  s_xor_b32 s75, s71, 1
  s_lshl_b32 s75, s75, 10
  s_add_u32 s75, s75, s73
  buffer_store_dwordx4 v[156:159], v16, s[28:31], s75 offen sc1
  v_fmac_f32 v72, v112, v124
  v_fmac_f32 v73, v113, v124
  v_fmac_f32 v74, v114, v124
  v_fmac_f32 v75, v115, v124
  v_fmac_f32 v88, v116, v124
  v_fmac_f32 v89, v117, v124
  v_fmac_f32 v90, v118, v124
  v_fmac_f32 v91, v119, v124
  v_add_f32_e64 v72, v72, |v72|
  v_add_f32_e64 v73, v73, |v73|
  v_add_f32_e64 v74, v74, |v74|
  v_add_f32_e64 v75, v75, |v75|
  v_add_f32_e64 v88, v88, |v88|
  v_add_f32_e64 v89, v89, |v89|
  v_add_f32_e64 v90, v90, |v90|
  v_add_f32_e64 v91, v91, |v91|
  v_mul_f32 v72, v72, v133
  v_mul_f32 v73, v73, v133
  v_mul_f32 v74, v74, v133
  v_mul_f32 v75, v75, v133
  v_mul_f32 v88, v88, v133
  v_mul_f32 v89, v89, v133
  v_mul_f32 v90, v90, v133
  v_mul_f32 v91, v91, v133
  v_cvt_pk_bf16_f32 v160, v72, v73
  v_cvt_pk_bf16_f32 v161, v74, v75
  v_cvt_pk_bf16_f32 v162, v88, v89
  v_cvt_pk_bf16_f32 v163, v90, v91
  s_xor_b32 s75, s71, 2
  s_lshl_b32 s75, s75, 10
  s_add_u32 s75, s75, s73
  buffer_store_dwordx4 v[160:163], v16, s[28:31], s75 offen sc1
  v_fmac_f32 v76, v112, v126
  v_fmac_f32 v77, v113, v126
  v_fmac_f32 v78, v114, v126
  v_fmac_f32 v79, v115, v126
  v_fmac_f32 v92, v116, v126
  v_fmac_f32 v93, v117, v126
  v_fmac_f32 v94, v118, v126
  v_fmac_f32 v95, v119, v126
  v_add_f32_e64 v76, v76, |v76|
  v_add_f32_e64 v77, v77, |v77|
  v_add_f32_e64 v78, v78, |v78|
  v_add_f32_e64 v79, v79, |v79|
  v_add_f32_e64 v92, v92, |v92|
  v_add_f32_e64 v93, v93, |v93|
  v_add_f32_e64 v94, v94, |v94|
  v_add_f32_e64 v95, v95, |v95|
  v_mul_f32 v76, v76, v135
  v_mul_f32 v77, v77, v135
  v_mul_f32 v78, v78, v135
  v_mul_f32 v79, v79, v135
  v_mul_f32 v92, v92, v135
  v_mul_f32 v93, v93, v135
  v_mul_f32 v94, v94, v135
  v_mul_f32 v95, v95, v135
  v_cvt_pk_bf16_f32 v164, v76, v77
  v_cvt_pk_bf16_f32 v165, v78, v79
  v_cvt_pk_bf16_f32 v166, v92, v93
  v_cvt_pk_bf16_f32 v167, v94, v95
  s_xor_b32 s75, s71, 3
  s_lshl_b32 s75, s75, 10
  s_add_u32 s75, s75, s73
  buffer_store_dwordx4 v[164:167], v16, s[28:31], s75 offen sc1
  s_cmp_ge_u32 s46, 2
  s_cselect_b32 s63, 6, 4
  s_cmp_ge_u32 s46, 5
  s_cselect_b32 s63, 4, s63
  s_waitcnt vmcnt(0)
  v_mov_b32 v10, 112640
  v_mov_b32 v11, 1
  s_mov_b64 exec, 1
  ds_add_rtn_u32 v8, v10, v11 offset:16
  s_mov_b64 exec, -1
  s_waitcnt lgkmcnt(0)
  v_readfirstlane_b32 s62, v8
  s_nop 3
  s_add_u32 s62, s62, 1
  s_cmp_eq_u32 s62, s63
  s_cbranch_scc0 K1_HQ_SH
  s_lshl_b32 s62, s45, 7
  s_add_u32 s62, s62, 16846848
  s_mov_b64 exec, 1
  buffer_atomic_add v11, v31, s[28:31], s62 offen
  s_mov_b64 exec, -1
K1_HQ_SH:
  s_branch K1_HQ_FIN
K1_HQ_Q:
  v_mov_b32 v255, 0x358637bd
  s_xor_b32 s72, s70, 0
  s_lshl_b32 s73, s57, 1
  s_add_u32 s72, s72, s73
  s_mul_i32 s73, s61, 40
  s_add_u32 s73, s73, s72
  s_lshl_b32 s73, s73, 11
  s_add_u32 s73, s73, 10485760
  v_fmac_f32 v32, v104, v120
  v_fmac_f32 v33, v105, v120
  v_fmac_f32 v34, v106, v120
  v_fmac_f32 v35, v107, v120
  v_fmac_f32 v48, v108, v120
  v_fmac_f32 v49, v109, v120
  v_fmac_f32 v50, v110, v120
  v_fmac_f32 v51, v111, v120
  v_mul_f32 v168, v32, v128
  v_mul_f32 v169, v33, v128
  v_mul_f32 v170, v34, v128
  v_mul_f32 v171, v35, v128
  v_mul_f32 v172, v48, v128
  v_mul_f32 v173, v49, v128
  v_mul_f32 v174, v50, v128
  v_mul_f32 v175, v51, v128
  v_exp_f32_e64 v168, v168 clamp
  v_add_f32_e64 v32, v32, |v32|
  v_exp_f32_e64 v169, v169 clamp
  v_add_f32_e64 v33, v33, |v33|
  v_exp_f32_e64 v170, v170 clamp
  v_add_f32_e64 v34, v34, |v34|
  v_exp_f32_e64 v171, v171 clamp
  v_add_f32_e64 v35, v35, |v35|
  v_exp_f32_e64 v172, v172 clamp
  v_add_f32_e64 v48, v48, |v48|
  v_exp_f32_e64 v173, v173 clamp
  v_add_f32_e64 v49, v49, |v49|
  v_exp_f32_e64 v174, v174 clamp
  v_add_f32_e64 v50, v50, |v50|
  v_exp_f32_e64 v175, v175 clamp
  v_add_f32_e64 v51, v51, |v51|
  v_add_f32 v168, v255, v168
  v_add_f32 v169, v255, v169
  v_add_f32 v170, v255, v170
  v_add_f32 v171, v255, v171
  v_add_f32 v172, v255, v172
  v_add_f32 v173, v255, v173
  v_add_f32 v174, v255, v174
  v_add_f32 v175, v255, v175
  v_fmac_f32 v168, v32, v129
  v_fmac_f32 v169, v33, v129
  v_fmac_f32 v170, v34, v129
  v_fmac_f32 v171, v35, v129
  v_fmac_f32 v172, v48, v129
  v_fmac_f32 v173, v49, v129
  v_fmac_f32 v174, v50, v129
  v_fmac_f32 v175, v51, v129
  v_cvt_pk_bf16_f32 v136, v168, v169
  v_cvt_pk_bf16_f32 v137, v170, v171
  v_cvt_pk_bf16_f32 v138, v172, v173
  v_cvt_pk_bf16_f32 v139, v174, v175
  s_xor_b32 s75, s71, 0
  s_lshr_b32 s74, s75, 1
  s_mul_i32 s74, s74, 40960
  s_and_b32 s75, s75, 1
  s_lshl_b32 s75, s75, 10
  s_add_u32 s75, s75, s74
  s_add_u32 s75, s75, s73
  buffer_store_dwordx4 v[136:139], v16, s[28:31], s75 offen sc1
  v_fmac_f32 v36, v104, v122
  v_fmac_f32 v37, v105, v122
  v_fmac_f32 v38, v106, v122
  v_fmac_f32 v39, v107, v122
  v_fmac_f32 v52, v108, v122
  v_fmac_f32 v53, v109, v122
  v_fmac_f32 v54, v110, v122
  v_fmac_f32 v55, v111, v122
  v_mul_f32 v168, v36, v130
  v_mul_f32 v169, v37, v130
  v_mul_f32 v170, v38, v130
  v_mul_f32 v171, v39, v130
  v_mul_f32 v172, v52, v130
  v_mul_f32 v173, v53, v130
  v_mul_f32 v174, v54, v130
  v_mul_f32 v175, v55, v130
  v_exp_f32_e64 v168, v168 clamp
  v_add_f32_e64 v36, v36, |v36|
  v_exp_f32_e64 v169, v169 clamp
  v_add_f32_e64 v37, v37, |v37|
  v_exp_f32_e64 v170, v170 clamp
  v_add_f32_e64 v38, v38, |v38|
  v_exp_f32_e64 v171, v171 clamp
  v_add_f32_e64 v39, v39, |v39|
  v_exp_f32_e64 v172, v172 clamp
  v_add_f32_e64 v52, v52, |v52|
  v_exp_f32_e64 v173, v173 clamp
  v_add_f32_e64 v53, v53, |v53|
  v_exp_f32_e64 v174, v174 clamp
  v_add_f32_e64 v54, v54, |v54|
  v_exp_f32_e64 v175, v175 clamp
  v_add_f32_e64 v55, v55, |v55|
  v_add_f32 v168, v255, v168
  v_add_f32 v169, v255, v169
  v_add_f32 v170, v255, v170
  v_add_f32 v171, v255, v171
  v_add_f32 v172, v255, v172
  v_add_f32 v173, v255, v173
  v_add_f32 v174, v255, v174
  v_add_f32 v175, v255, v175
  v_fmac_f32 v168, v36, v131
  v_fmac_f32 v169, v37, v131
  v_fmac_f32 v170, v38, v131
  v_fmac_f32 v171, v39, v131
  v_fmac_f32 v172, v52, v131
  v_fmac_f32 v173, v53, v131
  v_fmac_f32 v174, v54, v131
  v_fmac_f32 v175, v55, v131
  v_cvt_pk_bf16_f32 v140, v168, v169
  v_cvt_pk_bf16_f32 v141, v170, v171
  v_cvt_pk_bf16_f32 v142, v172, v173
  v_cvt_pk_bf16_f32 v143, v174, v175
  s_xor_b32 s75, s71, 1
  s_lshr_b32 s74, s75, 1
  s_mul_i32 s74, s74, 40960
  s_and_b32 s75, s75, 1
  s_lshl_b32 s75, s75, 10
  s_add_u32 s75, s75, s74
  s_add_u32 s75, s75, s73
  buffer_store_dwordx4 v[140:143], v16, s[28:31], s75 offen sc1
  v_fmac_f32 v40, v104, v124
  v_fmac_f32 v41, v105, v124
  v_fmac_f32 v42, v106, v124
  v_fmac_f32 v43, v107, v124
  v_fmac_f32 v56, v108, v124
  v_fmac_f32 v57, v109, v124
  v_fmac_f32 v58, v110, v124
  v_fmac_f32 v59, v111, v124
  v_mul_f32 v168, v40, v132
  v_mul_f32 v169, v41, v132
  v_mul_f32 v170, v42, v132
  v_mul_f32 v171, v43, v132
  v_mul_f32 v172, v56, v132
  v_mul_f32 v173, v57, v132
  v_mul_f32 v174, v58, v132
  v_mul_f32 v175, v59, v132
  v_exp_f32_e64 v168, v168 clamp
  v_add_f32_e64 v40, v40, |v40|
  v_exp_f32_e64 v169, v169 clamp
  v_add_f32_e64 v41, v41, |v41|
  v_exp_f32_e64 v170, v170 clamp
  v_add_f32_e64 v42, v42, |v42|
  v_exp_f32_e64 v171, v171 clamp
  v_add_f32_e64 v43, v43, |v43|
  v_exp_f32_e64 v172, v172 clamp
  v_add_f32_e64 v56, v56, |v56|
  v_exp_f32_e64 v173, v173 clamp
  v_add_f32_e64 v57, v57, |v57|
  v_exp_f32_e64 v174, v174 clamp
  v_add_f32_e64 v58, v58, |v58|
  v_exp_f32_e64 v175, v175 clamp
  v_add_f32_e64 v59, v59, |v59|
  v_add_f32 v168, v255, v168
  v_add_f32 v169, v255, v169
  v_add_f32 v170, v255, v170
  v_add_f32 v171, v255, v171
  v_add_f32 v172, v255, v172
  v_add_f32 v173, v255, v173
  v_add_f32 v174, v255, v174
  v_add_f32 v175, v255, v175
  v_fmac_f32 v168, v40, v133
  v_fmac_f32 v169, v41, v133
  v_fmac_f32 v170, v42, v133
  v_fmac_f32 v171, v43, v133
  v_fmac_f32 v172, v56, v133
  v_fmac_f32 v173, v57, v133
  v_fmac_f32 v174, v58, v133
  v_fmac_f32 v175, v59, v133
  v_cvt_pk_bf16_f32 v144, v168, v169
  v_cvt_pk_bf16_f32 v145, v170, v171
  v_cvt_pk_bf16_f32 v146, v172, v173
  v_cvt_pk_bf16_f32 v147, v174, v175
  s_xor_b32 s75, s71, 2
  s_lshr_b32 s74, s75, 1
  s_mul_i32 s74, s74, 40960
  s_and_b32 s75, s75, 1
  s_lshl_b32 s75, s75, 10
  s_add_u32 s75, s75, s74
  s_add_u32 s75, s75, s73
  buffer_store_dwordx4 v[144:147], v16, s[28:31], s75 offen sc1
  v_fmac_f32 v44, v104, v126
  v_fmac_f32 v45, v105, v126
  v_fmac_f32 v46, v106, v126
  v_fmac_f32 v47, v107, v126
  v_fmac_f32 v60, v108, v126
  v_fmac_f32 v61, v109, v126
  v_fmac_f32 v62, v110, v126
  v_fmac_f32 v63, v111, v126
  v_mul_f32 v168, v44, v134
  v_mul_f32 v169, v45, v134
  v_mul_f32 v170, v46, v134
  v_mul_f32 v171, v47, v134
  v_mul_f32 v172, v60, v134
  v_mul_f32 v173, v61, v134
  v_mul_f32 v174, v62, v134
  v_mul_f32 v175, v63, v134
  v_exp_f32_e64 v168, v168 clamp
  v_add_f32_e64 v44, v44, |v44|
  v_exp_f32_e64 v169, v169 clamp
  v_add_f32_e64 v45, v45, |v45|
  v_exp_f32_e64 v170, v170 clamp
  v_add_f32_e64 v46, v46, |v46|
  v_exp_f32_e64 v171, v171 clamp
  v_add_f32_e64 v47, v47, |v47|
  v_exp_f32_e64 v172, v172 clamp
  v_add_f32_e64 v60, v60, |v60|
  v_exp_f32_e64 v173, v173 clamp
  v_add_f32_e64 v61, v61, |v61|
  v_exp_f32_e64 v174, v174 clamp
  v_add_f32_e64 v62, v62, |v62|
  v_exp_f32_e64 v175, v175 clamp
  v_add_f32_e64 v63, v63, |v63|
  v_add_f32 v168, v255, v168
  v_add_f32 v169, v255, v169
  v_add_f32 v170, v255, v170
  v_add_f32 v171, v255, v171
  v_add_f32 v172, v255, v172
  v_add_f32 v173, v255, v173
  v_add_f32 v174, v255, v174
  v_add_f32 v175, v255, v175
  v_fmac_f32 v168, v44, v135
  v_fmac_f32 v169, v45, v135
  v_fmac_f32 v170, v46, v135
  v_fmac_f32 v171, v47, v135
  v_fmac_f32 v172, v60, v135
  v_fmac_f32 v173, v61, v135
  v_fmac_f32 v174, v62, v135
  v_fmac_f32 v175, v63, v135
  v_cvt_pk_bf16_f32 v148, v168, v169
  v_cvt_pk_bf16_f32 v149, v170, v171
  v_cvt_pk_bf16_f32 v150, v172, v173
  v_cvt_pk_bf16_f32 v151, v174, v175
  s_xor_b32 s75, s71, 3
  s_lshr_b32 s74, s75, 1
  s_mul_i32 s74, s74, 40960
  s_and_b32 s75, s75, 1
  s_lshl_b32 s75, s75, 10
  s_add_u32 s75, s75, s74
  s_add_u32 s75, s75, s73
  buffer_store_dwordx4 v[148:151], v16, s[28:31], s75 offen sc1
  s_xor_b32 s72, s70, 1
  s_lshl_b32 s73, s57, 1
  s_add_u32 s72, s72, s73
  s_mul_i32 s73, s61, 40
  s_add_u32 s73, s73, s72
  s_lshl_b32 s73, s73, 11
  s_add_u32 s73, s73, 10485760
  v_fmac_f32 v64, v112, v120
  v_fmac_f32 v65, v113, v120
  v_fmac_f32 v66, v114, v120
  v_fmac_f32 v67, v115, v120
  v_fmac_f32 v80, v116, v120
  v_fmac_f32 v81, v117, v120
  v_fmac_f32 v82, v118, v120
  v_fmac_f32 v83, v119, v120
  v_mul_f32 v168, v64, v128
  v_mul_f32 v169, v65, v128
  v_mul_f32 v170, v66, v128
  v_mul_f32 v171, v67, v128
  v_mul_f32 v172, v80, v128
  v_mul_f32 v173, v81, v128
  v_mul_f32 v174, v82, v128
  v_mul_f32 v175, v83, v128
  v_exp_f32_e64 v168, v168 clamp
  v_add_f32_e64 v64, v64, |v64|
  v_exp_f32_e64 v169, v169 clamp
  v_add_f32_e64 v65, v65, |v65|
  v_exp_f32_e64 v170, v170 clamp
  v_add_f32_e64 v66, v66, |v66|
  v_exp_f32_e64 v171, v171 clamp
  v_add_f32_e64 v67, v67, |v67|
  v_exp_f32_e64 v172, v172 clamp
  v_add_f32_e64 v80, v80, |v80|
  v_exp_f32_e64 v173, v173 clamp
  v_add_f32_e64 v81, v81, |v81|
  v_exp_f32_e64 v174, v174 clamp
  v_add_f32_e64 v82, v82, |v82|
  v_exp_f32_e64 v175, v175 clamp
  v_add_f32_e64 v83, v83, |v83|
  v_add_f32 v168, v255, v168
  v_add_f32 v169, v255, v169
  v_add_f32 v170, v255, v170
  v_add_f32 v171, v255, v171
  v_add_f32 v172, v255, v172
  v_add_f32 v173, v255, v173
  v_add_f32 v174, v255, v174
  v_add_f32 v175, v255, v175
  v_fmac_f32 v168, v64, v129
  v_fmac_f32 v169, v65, v129
  v_fmac_f32 v170, v66, v129
  v_fmac_f32 v171, v67, v129
  v_fmac_f32 v172, v80, v129
  v_fmac_f32 v173, v81, v129
  v_fmac_f32 v174, v82, v129
  v_fmac_f32 v175, v83, v129
  v_cvt_pk_bf16_f32 v152, v168, v169
  v_cvt_pk_bf16_f32 v153, v170, v171
  v_cvt_pk_bf16_f32 v154, v172, v173
  v_cvt_pk_bf16_f32 v155, v174, v175
  s_xor_b32 s75, s71, 0
  s_lshr_b32 s74, s75, 1
  s_mul_i32 s74, s74, 40960
  s_and_b32 s75, s75, 1
  s_lshl_b32 s75, s75, 10
  s_add_u32 s75, s75, s74
  s_add_u32 s75, s75, s73
  buffer_store_dwordx4 v[152:155], v16, s[28:31], s75 offen sc1
  v_fmac_f32 v68, v112, v122
  v_fmac_f32 v69, v113, v122
  v_fmac_f32 v70, v114, v122
  v_fmac_f32 v71, v115, v122
  v_fmac_f32 v84, v116, v122
  v_fmac_f32 v85, v117, v122
  v_fmac_f32 v86, v118, v122
  v_fmac_f32 v87, v119, v122
  v_mul_f32 v168, v68, v130
  v_mul_f32 v169, v69, v130
  v_mul_f32 v170, v70, v130
  v_mul_f32 v171, v71, v130
  v_mul_f32 v172, v84, v130
  v_mul_f32 v173, v85, v130
  v_mul_f32 v174, v86, v130
  v_mul_f32 v175, v87, v130
  v_exp_f32_e64 v168, v168 clamp
  v_add_f32_e64 v68, v68, |v68|
  v_exp_f32_e64 v169, v169 clamp
  v_add_f32_e64 v69, v69, |v69|
  v_exp_f32_e64 v170, v170 clamp
  v_add_f32_e64 v70, v70, |v70|
  v_exp_f32_e64 v171, v171 clamp
  v_add_f32_e64 v71, v71, |v71|
  v_exp_f32_e64 v172, v172 clamp
  v_add_f32_e64 v84, v84, |v84|
  v_exp_f32_e64 v173, v173 clamp
  v_add_f32_e64 v85, v85, |v85|
  v_exp_f32_e64 v174, v174 clamp
  v_add_f32_e64 v86, v86, |v86|
  v_exp_f32_e64 v175, v175 clamp
  v_add_f32_e64 v87, v87, |v87|
  v_add_f32 v168, v255, v168
  v_add_f32 v169, v255, v169
  v_add_f32 v170, v255, v170
  v_add_f32 v171, v255, v171
  v_add_f32 v172, v255, v172
  v_add_f32 v173, v255, v173
  v_add_f32 v174, v255, v174
  v_add_f32 v175, v255, v175
  v_fmac_f32 v168, v68, v131
  v_fmac_f32 v169, v69, v131
  v_fmac_f32 v170, v70, v131
  v_fmac_f32 v171, v71, v131
  v_fmac_f32 v172, v84, v131
  v_fmac_f32 v173, v85, v131
  v_fmac_f32 v174, v86, v131
  v_fmac_f32 v175, v87, v131
  v_cvt_pk_bf16_f32 v156, v168, v169
  v_cvt_pk_bf16_f32 v157, v170, v171
  v_cvt_pk_bf16_f32 v158, v172, v173
  v_cvt_pk_bf16_f32 v159, v174, v175
  s_xor_b32 s75, s71, 1
  s_lshr_b32 s74, s75, 1
  s_mul_i32 s74, s74, 40960
  s_and_b32 s75, s75, 1
  s_lshl_b32 s75, s75, 10
  s_add_u32 s75, s75, s74
  s_add_u32 s75, s75, s73
  buffer_store_dwordx4 v[156:159], v16, s[28:31], s75 offen sc1
  v_fmac_f32 v72, v112, v124
  v_fmac_f32 v73, v113, v124
  v_fmac_f32 v74, v114, v124
  v_fmac_f32 v75, v115, v124
  v_fmac_f32 v88, v116, v124
  v_fmac_f32 v89, v117, v124
  v_fmac_f32 v90, v118, v124
  v_fmac_f32 v91, v119, v124
  v_mul_f32 v168, v72, v132
  v_mul_f32 v169, v73, v132
  v_mul_f32 v170, v74, v132
  v_mul_f32 v171, v75, v132
  v_mul_f32 v172, v88, v132
  v_mul_f32 v173, v89, v132
  v_mul_f32 v174, v90, v132
  v_mul_f32 v175, v91, v132
  v_exp_f32_e64 v168, v168 clamp
  v_add_f32_e64 v72, v72, |v72|
  v_exp_f32_e64 v169, v169 clamp
  v_add_f32_e64 v73, v73, |v73|
  v_exp_f32_e64 v170, v170 clamp
  v_add_f32_e64 v74, v74, |v74|
  v_exp_f32_e64 v171, v171 clamp
  v_add_f32_e64 v75, v75, |v75|
  v_exp_f32_e64 v172, v172 clamp
  v_add_f32_e64 v88, v88, |v88|
  v_exp_f32_e64 v173, v173 clamp
  v_add_f32_e64 v89, v89, |v89|
  v_exp_f32_e64 v174, v174 clamp
  v_add_f32_e64 v90, v90, |v90|
  v_exp_f32_e64 v175, v175 clamp
  v_add_f32_e64 v91, v91, |v91|
  v_add_f32 v168, v255, v168
  v_add_f32 v169, v255, v169
  v_add_f32 v170, v255, v170
  v_add_f32 v171, v255, v171
  v_add_f32 v172, v255, v172
  v_add_f32 v173, v255, v173
  v_add_f32 v174, v255, v174
  v_add_f32 v175, v255, v175
  v_fmac_f32 v168, v72, v133
  v_fmac_f32 v169, v73, v133
  v_fmac_f32 v170, v74, v133
  v_fmac_f32 v171, v75, v133
  v_fmac_f32 v172, v88, v133
  v_fmac_f32 v173, v89, v133
  v_fmac_f32 v174, v90, v133
  v_fmac_f32 v175, v91, v133
  v_cvt_pk_bf16_f32 v160, v168, v169
  v_cvt_pk_bf16_f32 v161, v170, v171
  v_cvt_pk_bf16_f32 v162, v172, v173
  v_cvt_pk_bf16_f32 v163, v174, v175
  s_xor_b32 s75, s71, 2
  s_lshr_b32 s74, s75, 1
  s_mul_i32 s74, s74, 40960
  s_and_b32 s75, s75, 1
  s_lshl_b32 s75, s75, 10
  s_add_u32 s75, s75, s74
  s_add_u32 s75, s75, s73
  buffer_store_dwordx4 v[160:163], v16, s[28:31], s75 offen sc1
  v_fmac_f32 v76, v112, v126
  v_fmac_f32 v77, v113, v126
  v_fmac_f32 v78, v114, v126
  v_fmac_f32 v79, v115, v126
  v_fmac_f32 v92, v116, v126
  v_fmac_f32 v93, v117, v126
  v_fmac_f32 v94, v118, v126
  v_fmac_f32 v95, v119, v126
  v_mul_f32 v168, v76, v134
  v_mul_f32 v169, v77, v134
  v_mul_f32 v170, v78, v134
  v_mul_f32 v171, v79, v134
  v_mul_f32 v172, v92, v134
  v_mul_f32 v173, v93, v134
  v_mul_f32 v174, v94, v134
  v_mul_f32 v175, v95, v134
  v_exp_f32_e64 v168, v168 clamp
  v_add_f32_e64 v76, v76, |v76|
  v_exp_f32_e64 v169, v169 clamp
  v_add_f32_e64 v77, v77, |v77|
  v_exp_f32_e64 v170, v170 clamp
  v_add_f32_e64 v78, v78, |v78|
  v_exp_f32_e64 v171, v171 clamp
  v_add_f32_e64 v79, v79, |v79|
  v_exp_f32_e64 v172, v172 clamp
  v_add_f32_e64 v92, v92, |v92|
  v_exp_f32_e64 v173, v173 clamp
  v_add_f32_e64 v93, v93, |v93|
  v_exp_f32_e64 v174, v174 clamp
  v_add_f32_e64 v94, v94, |v94|
  v_exp_f32_e64 v175, v175 clamp
  v_add_f32_e64 v95, v95, |v95|
  v_add_f32 v168, v255, v168
  v_add_f32 v169, v255, v169
  v_add_f32 v170, v255, v170
  v_add_f32 v171, v255, v171
  v_add_f32 v172, v255, v172
  v_add_f32 v173, v255, v173
  v_add_f32 v174, v255, v174
  v_add_f32 v175, v255, v175
  v_fmac_f32 v168, v76, v135
  v_fmac_f32 v169, v77, v135
  v_fmac_f32 v170, v78, v135
  v_fmac_f32 v171, v79, v135
  v_fmac_f32 v172, v92, v135
  v_fmac_f32 v173, v93, v135
  v_fmac_f32 v174, v94, v135
  v_fmac_f32 v175, v95, v135
  v_cvt_pk_bf16_f32 v164, v168, v169
  v_cvt_pk_bf16_f32 v165, v170, v171
  v_cvt_pk_bf16_f32 v166, v172, v173
  v_cvt_pk_bf16_f32 v167, v174, v175
  s_xor_b32 s75, s71, 3
  s_lshr_b32 s74, s75, 1
  s_mul_i32 s74, s74, 40960
  s_and_b32 s75, s75, 1
  s_lshl_b32 s75, s75, 10
  s_add_u32 s75, s75, s74
  s_add_u32 s75, s75, s73
  buffer_store_dwordx4 v[164:167], v16, s[28:31], s75 offen sc1
  s_cmp_ge_u32 s46, 2
  s_cselect_b32 s63, 2, 4
  s_waitcnt vmcnt(0)
  v_mov_b32 v10, 112640
  v_mov_b32 v11, 1
  s_mov_b64 exec, 1
  ds_add_rtn_u32 v8, v10, v11 offset:20
  s_mov_b64 exec, -1
  s_waitcnt lgkmcnt(0)
  v_readfirstlane_b32 s62, v8
  s_nop 3
  s_add_u32 s62, s62, 1
  s_cmp_eq_u32 s62, s63
  s_cbranch_scc0 K1_HQ_SQ
  s_lshl_b32 s62, s45, 7
  s_add_u32 s62, s62, 16852992
  s_mov_b64 exec, 1
  buffer_atomic_add v11, v31, s[28:31], s62 offen
  s_mov_b64 exec, -1
K1_HQ_SQ:
K1_HQ_FIN:
K1_HQ_END:
  s_branch PH2
K1_HQL_XT0:
  v_mfma_f32_16x16x32_bf16 v[96:99], v[104:107], v[12:15], v[96:99]
  v_mfma_f32_16x16x32_bf16 v[100:103], v[108:111], v[12:15], v[100:103]
  v_mfma_f32_16x16x32_bf16 v[240:243], v[136:139], v[136:139], v[240:243]
  v_mfma_f32_16x16x32_bf16 v[244:247], v[12:15], v[136:139], v[244:247]
  s_branch K1_HQL_XT0_B
K1_HQL_XT1:
  v_mfma_f32_16x16x32_bf16 v[96:99], v[120:123], v[12:15], v[96:99]
  v_mfma_f32_16x16x32_bf16 v[100:103], v[124:127], v[12:15], v[100:103]
  v_mfma_f32_16x16x32_bf16 v[240:243], v[152:155], v[152:155], v[240:243]
  v_mfma_f32_16x16x32_bf16 v[244:247], v[12:15], v[152:155], v[244:247]
  s_branch K1_HQL_XT1_B
K1_HQL_XT2:
  s_branch K1_HQL_XT2_B
K1_HQL_XT3:
  s_branch K1_HQL_XT3_B
K1_HQL_HK0:
  s_branch K1_HQL_HK0_B
K1_HQL_HK1:
  s_branch K1_HQL_HK1_B
K1_HQL_HK2:
  s_cmp_eq_u32 s19, 2
  s_cbranch_scc0 K1_HQL_HK2_a
  s_and_b32 s70, s44, 1
  s_lshr_b32 s71, s44, 1
  s_lshl_b32 s72, s70, 6
  s_lshl_b32 s73, s71, 4
  s_add_u32 s73, s73, s72
  s_mov_b32 s74, 0xaaaaaaaa
  s_mov_b32 s75, 0xaaaaaaaa
  s_mov_b32 s76, 0xcccccccc
  s_mov_b32 s77, 0xcccccccc
  v_cndmask_b32 v8, v240, v241, s[74:75]
  v_cndmask_b32 v9, v242, v243, s[74:75]
  v_and_b32 v10, 15, v1
  v_cndmask_b32 v9, v8, v9, s[76:77]
  v_mov_b32 v8, v244
  s_lshl_b32 s62, s73, 3
  s_add_u32 s62, s62, 110592
  v_lshl_add_u32 v10, v10, 3, s62
  s_mov_b32 exec_lo, 0xf0000f
  s_mov_b32 exec_hi, 0xf0000f00
  ds_write_b64 v10, v[8:9]
  s_mov_b64 exec, -1
  s_lshl_b32 s62, s71, 8
  s_add_u32 s62, s62, 111616
  v_lshrrev_b32 v10, 4, v1
  v_lshlrev_b32 v10, 4, v10
  s_lshl_b32 s74, s70, 1
  s_xor_b32 s75, s74, 0
  s_lshl_b32 s75, s75, 6
  s_add_u32 s75, s75, s62
  v_add_u32 v11, s75, v10
  s_mov_b32 exec_lo, 0x10001
  s_mov_b32 exec_hi, 0x10001
  ds_write_b128 v11, v[96:99]
  s_mov_b64 exec, -1
  s_xor_b32 s75, s74, 1
  s_lshl_b32 s75, s75, 6
  s_add_u32 s75, s75, s62
  v_add_u32 v11, s75, v10
  s_mov_b32 exec_lo, 0x10001
  s_mov_b32 exec_hi, 0x10001
  ds_write_b128 v11, v[100:103]
  s_mov_b64 exec, -1
K1_HQL_HK2_a:
  s_branch K1_HQL_HK2_B
K1_HQL_HK3:
  s_branch K1_HQL_HK3_B
K1_HQS_XT0:
  v_mfma_f32_16x16x32_bf16 v[96:99], v[104:107], v[12:15], v[96:99]
  v_mfma_f32_16x16x32_bf16 v[100:103], v[108:111], v[12:15], v[100:103]
  v_mfma_f32_16x16x32_bf16 v[240:243], v[136:139], v[136:139], v[240:243]
  v_mfma_f32_16x16x32_bf16 v[244:247], v[12:15], v[136:139], v[244:247]
  s_branch K1_HQS_XT0_B
K1_HQS_XT1:
  v_mfma_f32_16x16x32_bf16 v[96:99], v[120:123], v[12:15], v[96:99]
  v_mfma_f32_16x16x32_bf16 v[100:103], v[124:127], v[12:15], v[100:103]
  v_mfma_f32_16x16x32_bf16 v[240:243], v[152:155], v[152:155], v[240:243]
  v_mfma_f32_16x16x32_bf16 v[244:247], v[12:15], v[152:155], v[244:247]
  s_branch K1_HQS_XT1_B
K1_HQS_XT2:
  s_branch K1_HQS_XT2_B
K1_HQS_XT3:
  s_branch K1_HQS_XT3_B
K1_HQS_HK0:
  s_cmp_eq_u32 s19, 12
  s_cbranch_scc0 K1_HQS_HK0_b
  s_waitcnt vmcnt(0)
  s_mov_b32 s63, 2097152
K1_HQS_HK0_CW:
  v_cmp_eq_u32 vcc, 16, v29
  s_sub_u32 s63, s63, 1
  s_cmp_eq_u32 s63, 0
  s_cbranch_scc1 K1_HQS_HK0_CG
  s_nop 0
  s_cmp_eq_u64 vcc, -1
  s_cbranch_scc1 K1_HQS_HK0_CG
  s_sleep 4
  buffer_load_dword v29, v28, s[28:31], 0 offen sc1
  s_waitcnt vmcnt(0)
  s_branch K1_HQS_HK0_CW
K1_HQS_HK0_CG:
  s_mov_b32 vcc_hi, 0
K1_HQS_HK0_b:
  s_branch K1_HQS_HK0_B
K1_HQS_HK1:
  s_cmp_eq_u32 s19, 13
  s_cbranch_scc0 K1_HQS_HK1_b
  s_and_b32 s62, s44, 1
  s_lshl_b32 s62, s62, 6
  v_add_u32 v11, s62, v1
  v_lshlrev_b32 v11, 3, v11
  s_lshl_b32 s62, s45, 14
  s_add_u32 s62, s62, 17432576
  s_lshl_b32 s63, s18, 14
  s_add_u32 s63, s63, 17694720
  s_cmp_lt_u32 s44, 6
  s_cselect_b32 s62, s62, s63
  buffer_load_dwordx2 v[200:201], v11, s[28:31], s62 offen offset:0 sc1
  buffer_load_dwordx2 v[202:203], v11, s[28:31], s62 offen offset:1024 sc1
  buffer_load_dwordx2 v[204:205], v11, s[28:31], s62 offen offset:2048 sc1
  buffer_load_dwordx2 v[206:207], v11, s[28:31], s62 offen offset:3072 sc1
  s_add_u32 s62, s62, 4096
  buffer_load_dwordx2 v[208:209], v11, s[28:31], s62 offen offset:0 sc1
  buffer_load_dwordx2 v[210:211], v11, s[28:31], s62 offen offset:1024 sc1
  buffer_load_dwordx2 v[212:213], v11, s[28:31], s62 offen offset:2048 sc1
  buffer_load_dwordx2 v[214:215], v11, s[28:31], s62 offen offset:3072 sc1
  s_add_u32 s62, s62, 4096
  buffer_load_dwordx2 v[216:217], v11, s[28:31], s62 offen offset:0 sc1
  buffer_load_dwordx2 v[218:219], v11, s[28:31], s62 offen offset:1024 sc1
  v_and_b32 v10, 15, v1
  v_lshlrev_b32 v10, 7, v10
  s_mov_b32 s62, 16857088
  buffer_load_dword v220, v10, s[28:31], s62 offen sc1
K1_HQS_HK1_b:
  s_cmp_eq_u32 s44, 7
  s_cbranch_scc0 K1_HQS_HK1_w7
  s_cmp_eq_u32 s19, 9
  s_cbranch_scc0 K1_HQS_HK1_g
  buffer_load_dword v29, v28, s[28:31], 0 offen sc1
K1_HQS_HK1_g:
K1_HQS_HK1_w7:
  s_branch K1_HQS_HK1_B
K1_HQS_HK2:
  s_cmp_eq_u32 s19, 2
  s_cbranch_scc0 K1_HQS_HK2_a
  s_and_b32 s70, s44, 1
  s_lshr_b32 s71, s44, 1
  s_lshl_b32 s72, s70, 6
  s_lshl_b32 s73, s71, 4
  s_add_u32 s73, s73, s72
  s_mov_b32 s74, 0xaaaaaaaa
  s_mov_b32 s75, 0xaaaaaaaa
  s_mov_b32 s76, 0xcccccccc
  s_mov_b32 s77, 0xcccccccc
  v_cndmask_b32 v8, v240, v241, s[74:75]
  v_cndmask_b32 v9, v242, v243, s[74:75]
  v_and_b32 v10, 15, v1
  v_cndmask_b32 v9, v8, v9, s[76:77]
  v_mov_b32 v8, v244
  s_lshl_b32 s62, s73, 3
  s_add_u32 s62, s62, 110592
  v_lshl_add_u32 v10, v10, 3, s62
  s_mov_b32 exec_lo, 0xf0000f
  s_mov_b32 exec_hi, 0xf0000f00
  ds_write_b64 v10, v[8:9]
  s_mov_b64 exec, -1
  s_lshl_b32 s62, s71, 8
  s_add_u32 s62, s62, 111616
  v_lshrrev_b32 v10, 4, v1
  v_lshlrev_b32 v10, 4, v10
  s_lshl_b32 s74, s70, 1
  s_xor_b32 s75, s74, 0
  s_lshl_b32 s75, s75, 6
  s_add_u32 s75, s75, s62
  v_add_u32 v11, s75, v10
  s_mov_b32 exec_lo, 0x10001
  s_mov_b32 exec_hi, 0x10001
  ds_write_b128 v11, v[96:99]
  s_mov_b64 exec, -1
  s_xor_b32 s75, s74, 1
  s_lshl_b32 s75, s75, 6
  s_add_u32 s75, s75, s62
  v_add_u32 v11, s75, v10
  s_mov_b32 exec_lo, 0x10001
  s_mov_b32 exec_hi, 0x10001
  ds_write_b128 v11, v[100:103]
  s_mov_b64 exec, -1
K1_HQS_HK2_a:
  s_cmp_eq_u32 s44, 7
  s_cbranch_scc0 K1_HQS_HK2_w7
  s_cmp_eq_u32 s19, 6
  s_cbranch_scc0 K1_HQS_HK2_f
  s_waitcnt vmcnt(0)
  s_mov_b32 s63, 2097152
K1_HQS_HK2_W:
  v_readfirstlane_b32 s62, v30
  s_sub_u32 s63, s63, 1
  s_cmp_eq_u32 s63, 0
  s_cbranch_scc1 K1_HQS_HK2_G
  s_nop 0
  s_cmp_ge_u32 s62, 20
  s_cbranch_scc1 K1_HQS_HK2_G
  s_sleep 4
  buffer_load_dword v30, v31, s[32:35], 0 offen sc1
  s_waitcnt vmcnt(0)
  s_branch K1_HQS_HK2_W
K1_HQS_HK2_G:
  v_mov_b32 v10, 1
  s_mov_b64 exec, 3
  buffer_atomic_add v10, v28, s[28:31], 0 offen
  s_mov_b64 exec, -1
K1_HQS_HK2_f:
K1_HQS_HK2_w7:
  s_cmp_lt_u32 s60, 740
  s_cbranch_scc0 K1_HQS_HK2_B
  s_cmp_eq_u32 s19, 2
  s_cbranch_scc0 K1_HQS_HK2_d
  s_waitcnt vmcnt(0)
  v_lshrrev_b32 v252, 4, v1
  v_bfe_u32 v253, v1, 2, 2
  v_lshl_add_u32 v252, v252, 2, v253
  v_lshlrev_b32 v252, 7, v252
  v_and_b32 v253, 3, v1
  v_lshl_add_u32 v252, v253, 3, v252
  s_lshl_b32 s66, s44, 12
  s_add_u32 s66, s66, 81920
  v_add_u32 v252, s66, v252
  ds_read_b64_tr_b16 v[228:229], v252 offset:0
  ds_read_b64_tr_b16 v[230:231], v252 offset:2048
  ds_read_b64_tr_b16 v[232:233], v252 offset:32
  ds_read_b64_tr_b16 v[234:235], v252 offset:2080
  ds_read_b64_tr_b16 v[236:237], v252 offset:64
  ds_read_b64_tr_b16 v[238:239], v252 offset:2112
  ds_read_b64_tr_b16 v[248:249], v252 offset:96
  ds_read_b64_tr_b16 v[250:251], v252 offset:2144
  s_cmp_lt_u32 s98, 54
  s_cbranch_scc0 K1_HQS_HK2_JO
  s_mov_b32 s66, s98
  s_cmp_ge_u32 s98, 14
  s_cselect_b32 s67, 5, 0
  s_add_u32 s66, s66, s67
  s_cmp_ge_u32 s98, 28
  s_cselect_b32 s67, 5, 0
  s_add_u32 s66, s66, s67
  s_cmp_ge_u32 s98, 41
  s_cselect_b32 s67, 5, 0
  s_add_u32 s66, s66, s67
  s_branch K1_HQS_HK2_JS
K1_HQS_HK2_JO:
  s_add_u32 s66, s100, 14
  s_cmp_ge_u32 s100, 5
  s_cselect_b32 s67, 14, 0
  s_add_u32 s66, s66, s67
  s_cmp_ge_u32 s100, 10
  s_cselect_b32 s67, 13, 0
  s_add_u32 s66, s66, s67
  s_cmp_ge_u32 s100, 15
  s_cselect_b32 s67, 13, 0
  s_add_u32 s66, s66, s67
K1_HQS_HK2_JS:
  s_mul_i32 s66, s66, 40
  s_lshl_b32 s67, s99, 2
  s_add_u32 s66, s66, s67
  s_lshl_b32 s66, s66, 10
  s_add_u32 s66, s66, 13631488
  v_lshlrev_b32 v253, 4, v1
  s_waitcnt lgkmcnt(0)
  buffer_store_dwordx4 v[228:231], v253, s[28:31], s66 offen offset:0 sc1
  buffer_store_dwordx4 v[232:235], v253, s[28:31], s66 offen offset:1024 sc1
  buffer_store_dwordx4 v[236:239], v253, s[28:31], s66 offen offset:2048 sc1
  buffer_store_dwordx4 v[248:251], v253, s[28:31], s66 offen offset:3072 sc1
K1_HQS_HK2_d:
  s_cmp_eq_u32 s19, 6
  s_cbranch_scc0 K1_HQS_HK2_e
  s_waitcnt vmcnt(0)
K1_HQS_HK2_e:
  s_branch K1_HQS_HK2_B
K1_HQS_HK3:
  s_cmp_eq_u32 s19, 3
  s_cbranch_scc0 K1_HQS_HK3_b
  v_lshlrev_b32 v10, 4, v1
  v_add_u32 v11, 110592, v10
  ds_read_b128 v[228:231], v11
  ds_read_b128 v[232:235], v11 offset:1024
  s_lshl_b32 s62, s45, 4
  s_add_u32 s62, s62, s18
  s_lshl_b32 s62, s62, 10
  s_add_u32 s62, s62, 17432576
  s_lshl_b32 s63, s18, 4
  s_add_u32 s63, s63, s45
  s_lshl_b32 s63, s63, 10
  s_add_u32 s63, s63, 17694720
  s_waitcnt lgkmcnt(0)
  buffer_store_dwordx4 v[228:231], v10, s[28:31], s62 offen sc1
  buffer_store_dwordx4 v[232:235], v10, s[28:31], s63 offen sc1
  buffer_load_dword v30, v31, s[32:35], 0 offen sc1
K1_HQS_HK3_b:
  s_cmp_eq_u32 s19, 7
  s_cbranch_scc0 K1_HQS_HK3_c
  s_lshl_b32 s62, s45, 7
  s_add_u32 s62, s62, 16857088
  v_mov_b32 v10, 1
  s_mov_b64 exec, 1
  buffer_atomic_add v10, v31, s[28:31], s62 offen
  s_mov_b64 exec, -1
K1_HQS_HK3_c:
  s_branch K1_HQS_HK3_B
PH2:
  s_mov_b32 s24, s44
  v_mov_b32 v3, v1
  v_lshlrev_b32 v1, 4, v3
  v_add_u32 v2, 4096, v1
  s_and_b32 s27, s2, 7
  s_lshr_b32 s28, s2, 3
  s_lshr_b32 s25, s27, 1
  s_lshl_b32 s25, s25, 3
  s_and_b32 s29, s28, 7
  s_add_u32 s25, s25, s29
  s_and_b32 s26, s27, 1
  s_lshl_b32 s26, s26, 2
  s_lshr_b32 s28, s28, 3
  s_add_u32 s26, s26, s28
  s_mov_b32 s12, s10
  s_mov_b32 s13, s11
  s_mov_b32 s14, 17956864
  s_mov_b32 s15, 0x20000
  s_mov_b32 s16, s4
  s_mov_b32 s17, s5
  s_mov_b32 s18, 2621440
  s_mov_b32 s19, 0x20000
  s_mov_b32 s20, s96
  s_mov_b32 s21, s97
  s_mov_b32 s22, 2621440
  s_mov_b32 s23, 0x20000
  v_mul_u32_u24 v5, 6554, v0
  v_lshrrev_b32 v5, 16, v5
  v_mul_u32_u24 v6, 10, v5
  v_sub_u32 v6, v0, v6
  v_add_u32 v7, 512, v0
  v_mul_u32_u24 v8, 6554, v7
  v_lshrrev_b32 v8, 16, v8
  v_mul_u32_u24 v9, 10, v8
  v_sub_u32 v9, v7, v9
  s_mul_i32 s27, s25, 81920
  s_mul_i32 s28, s26, 160
  s_add_u32 s27, s27, s28
  v_mul_u32_u24 v248, 1280, v5
  v_lshl_add_u32 v248, v6, 4, v248
  v_add_u32 v248, s27, v248
  v_mul_u32_u24 v249, 1280, v8
  v_lshl_add_u32 v249, v9, 4, v249
  v_add_u32 v249, s27, v249
  v_mov_b32 v10, 0x7ff00000
  v_cmp_gt_u32 vcc, 128, v0
  s_nop 1
  v_cndmask_b32 v249, v10, v249, vcc
  v_mul_u32_u24 v250, 336, v5
  v_lshl_add_u32 v250, v6, 5, v250
  v_mul_u32_u24 v251, 336, v8
  v_lshl_add_u32 v251, v9, 5, v251
  v_mov_b32 v10, 0
  v_cndmask_b32 v251, v10, v251, vcc
  buffer_load_dwordx4 v[240:243], v248, s[16:19], 0 offen
  buffer_load_dwordx4 v[244:247], v249, s[16:19], 0 offen
  s_cmp_ge_u32 s24, 4
  s_cbranch_scc1 K2_SIDE
  s_mul_i32 s27, s24, 19
  s_cmp_eq_u32 s24, 3
  s_cselect_b32 s27, 56, s27
  s_lshr_b32 s28, s24, 1
  s_add_u32 s28, s28, 1
  s_mul_i32 s34, s25, 74
  s_add_u32 s34, s34, s27
  s_lshl_b32 s34, s34, 12
  s_mul_i32 s35, s27, 40
  s_mul_i32 s33, s26, 5
  s_add_u32 s35, s35, s33
  s_lshl_b32 s35, s35, 10
  s_add_u32 s35, s35, 13631488
  s_cmp_gt_u32 s28, 0
  s_cselect_b32 s42, 1073741824, s34
  s_cselect_b32 s46, 1073741824, s35
  s_cselect_b32 s36, 0, 4096
  s_cselect_b32 s37, 0, 40960
  s_add_u32 s34, s34, s36
  s_add_u32 s35, s35, s37
  s_cmp_gt_u32 s28, 1
  s_cselect_b32 s43, 1073741824, s34
  s_cselect_b32 s47, 1073741824, s35
  s_cselect_b32 s36, 0, 4096
  s_cselect_b32 s37, 0, 40960
  s_add_u32 s34, s34, s36
  s_add_u32 s35, s35, s37
  s_mov_b32 s44, s34
  s_mov_b32 s48, s35
  s_add_u32 s34, s34, 4096
  s_add_u32 s35, s35, 40960
  s_mov_b32 s45, s34
  s_mov_b32 s49, s35
  s_add_u32 s34, s34, 4096
  s_add_u32 s35, s35, 40960
  s_mov_b32 s31, s46
  buffer_load_dwordx4 v[96:99], v1, s[12:15], s31 offen offset:0
  buffer_load_dwordx4 v[100:103], v1, s[12:15], s31 offen offset:1024
  buffer_load_dwordx4 v[104:107], v1, s[12:15], s31 offen offset:2048
  buffer_load_dwordx4 v[108:111], v1, s[12:15], s31 offen offset:3072
  buffer_load_dwordx4 v[112:115], v2, s[12:15], s31 offen
  s_mov_b32 s31, s47
  buffer_load_dwordx4 v[132:135], v1, s[12:15], s31 offen offset:0
  buffer_load_dwordx4 v[136:139], v1, s[12:15], s31 offen offset:1024
  buffer_load_dwordx4 v[140:143], v1, s[12:15], s31 offen offset:2048
  buffer_load_dwordx4 v[144:147], v1, s[12:15], s31 offen offset:3072
  buffer_load_dwordx4 v[148:151], v2, s[12:15], s31 offen
  s_mov_b32 s31, s48
  buffer_load_dwordx4 v[168:171], v1, s[12:15], s31 offen offset:0
  buffer_load_dwordx4 v[172:175], v1, s[12:15], s31 offen offset:1024
  buffer_load_dwordx4 v[176:179], v1, s[12:15], s31 offen offset:2048
  buffer_load_dwordx4 v[180:183], v1, s[12:15], s31 offen offset:3072
  buffer_load_dwordx4 v[184:187], v2, s[12:15], s31 offen
  s_mov_b32 s31, s49
  buffer_load_dwordx4 v[204:207], v1, s[12:15], s31 offen offset:0
  buffer_load_dwordx4 v[208:211], v1, s[12:15], s31 offen offset:1024
  buffer_load_dwordx4 v[212:215], v1, s[12:15], s31 offen offset:2048
  buffer_load_dwordx4 v[216:219], v1, s[12:15], s31 offen offset:3072
  buffer_load_dwordx4 v[220:223], v2, s[12:15], s31 offen
  v_mov_b32 v16, 0
  v_mov_b32 v17, 0
  v_mov_b32 v18, 0
  v_mov_b32 v19, 0
  v_mov_b32 v20, 0
  v_mov_b32 v21, 0
  v_mov_b32 v22, 0
  v_mov_b32 v23, 0
  v_mov_b32 v24, 0
  v_mov_b32 v25, 0
  v_mov_b32 v26, 0
  v_mov_b32 v27, 0
  v_mov_b32 v28, 0
  v_mov_b32 v29, 0
  v_mov_b32 v30, 0
  v_mov_b32 v31, 0
  v_mov_b32 v32, 0
  v_mov_b32 v33, 0
  v_mov_b32 v34, 0
  v_mov_b32 v35, 0
  v_mov_b32 v36, 0
  v_mov_b32 v37, 0
  v_mov_b32 v38, 0
  v_mov_b32 v39, 0
  v_mov_b32 v40, 0
  v_mov_b32 v41, 0
  v_mov_b32 v42, 0
  v_mov_b32 v43, 0
  v_mov_b32 v44, 0
  v_mov_b32 v45, 0
  v_mov_b32 v46, 0
  v_mov_b32 v47, 0
  v_mov_b32 v48, 0
  v_mov_b32 v49, 0
  v_mov_b32 v50, 0
  v_mov_b32 v51, 0
  v_mov_b32 v52, 0
  v_mov_b32 v53, 0
  v_mov_b32 v54, 0
  v_mov_b32 v55, 0
  v_mov_b32 v56, 0
  v_mov_b32 v57, 0
  v_mov_b32 v58, 0
  v_mov_b32 v59, 0
  v_mov_b32 v60, 0
  v_mov_b32 v61, 0
  v_mov_b32 v62, 0
  v_mov_b32 v63, 0
  v_mov_b32 v64, 0
  v_mov_b32 v65, 0
  v_mov_b32 v66, 0
  v_mov_b32 v67, 0
  v_mov_b32 v68, 0
  v_mov_b32 v69, 0
  v_mov_b32 v70, 0
  v_mov_b32 v71, 0
  v_mov_b32 v72, 0
  v_mov_b32 v73, 0
  v_mov_b32 v74, 0
  v_mov_b32 v75, 0
  v_mov_b32 v76, 0
  v_mov_b32 v77, 0
  v_mov_b32 v78, 0
  v_mov_b32 v79, 0
  v_mov_b32 v80, 0
  v_mov_b32 v81, 0
  v_mov_b32 v82, 0
  v_mov_b32 v83, 0
  v_mov_b32 v84, 0
  v_mov_b32 v85, 0
  v_mov_b32 v86, 0
  v_mov_b32 v87, 0
  v_mov_b32 v88, 0
  v_mov_b32 v89, 0
  v_mov_b32 v90, 0
  v_mov_b32 v91, 0
  v_mov_b32 v92, 0
  v_mov_b32 v93, 0
  v_mov_b32 v94, 0
  v_mov_b32 v95, 0
  s_cmp_eq_u32 s24, 0
  s_cbranch_scc0 K2_HOTHER
  s_lshr_b32 s40, s25, 1
  s_lshl_b32 s40, s40, 7
  s_add_u32 s40, s40, 16846848
  v_mov_b32 v6, s40
  v_mov_b32 v8, 16
  s_mov_b32 s39, 2097152
K2_PH:
  buffer_load_dword v7, v6, s[12:15], 0 offen sc1
  s_waitcnt vmcnt(0)
  v_cmp_eq_u32 vcc, v8, v7
  s_sub_u32 s39, s39, 1
  s_cmp_eq_u32 s39, 0
  s_cbranch_scc1 K2_PH_X
  s_nop 0
  s_cmp_eq_u64 vcc, -1
  s_cbranch_scc1 K2_PH_X
  s_sleep 2
  s_branch K2_PH
K2_PH_X:
  v_mov_b32 v4, 112640
  v_mov_b32 v5, 1
  ds_write_b32 v4, v5 offset:8
K2_HOTHER:
  v_mov_b32 v4, 112640
  s_mov_b32 s39, 8388608
K2_HWAIT:
  ds_read_b32 v5, v4 offset:8
  s_waitcnt lgkmcnt(0)
  v_readfirstlane_b32 s40, v5
  s_sub_u32 s39, s39, 1
  s_cmp_eq_u32 s39, 0
  s_cbranch_scc1 K2_HWAIT_X
  s_nop 0
  s_cmp_eq_u32 s40, 0
  s_cbranch_scc0 K2_HWAIT_X
  s_sleep 1
  s_branch K2_HWAIT
K2_HWAIT_X:
  s_mov_b32 s30, s42
  buffer_load_dwordx4 v[116:119], v1, s[12:15], s30 offen offset:0 sc1
  buffer_load_dwordx4 v[120:123], v1, s[12:15], s30 offen offset:1024 sc1
  buffer_load_dwordx4 v[124:127], v1, s[12:15], s30 offen offset:2048 sc1
  buffer_load_dwordx4 v[128:131], v1, s[12:15], s30 offen offset:3072 sc1
  s_mov_b32 s30, s43
  buffer_load_dwordx4 v[152:155], v1, s[12:15], s30 offen offset:0 sc1
  buffer_load_dwordx4 v[156:159], v1, s[12:15], s30 offen offset:1024 sc1
  buffer_load_dwordx4 v[160:163], v1, s[12:15], s30 offen offset:2048 sc1
  buffer_load_dwordx4 v[164:167], v1, s[12:15], s30 offen offset:3072 sc1
  s_mov_b32 s30, s44
  buffer_load_dwordx4 v[188:191], v1, s[12:15], s30 offen offset:0 sc1
  buffer_load_dwordx4 v[192:195], v1, s[12:15], s30 offen offset:1024 sc1
  buffer_load_dwordx4 v[196:199], v1, s[12:15], s30 offen offset:2048 sc1
  buffer_load_dwordx4 v[200:203], v1, s[12:15], s30 offen offset:3072 sc1
  s_mov_b32 s30, s45
  buffer_load_dwordx4 v[224:227], v1, s[12:15], s30 offen offset:0 sc1
  buffer_load_dwordx4 v[228:231], v1, s[12:15], s30 offen offset:1024 sc1
  buffer_load_dwordx4 v[232:235], v1, s[12:15], s30 offen offset:2048 sc1
  buffer_load_dwordx4 v[236:239], v1, s[12:15], s30 offen offset:3072 sc1
  s_mov_b32 s30, s34
  s_mov_b32 s31, s35
  s_waitcnt vmcnt(12)
  v_mfma_f32_16x16x32_bf16 v[16:19], v[96:99], v[116:119], v[16:19]
  v_mfma_f32_16x16x32_bf16 v[20:23], v[96:99], v[120:123], v[20:23]
  v_mfma_f32_16x16x32_bf16 v[24:27], v[96:99], v[124:127], v[24:27]
  v_mfma_f32_16x16x32_bf16 v[28:31], v[96:99], v[128:131], v[28:31]
  buffer_load_dwordx4 v[96:99], v1, s[12:15], s31 offen offset:0
  v_mfma_f32_16x16x32_bf16 v[32:35], v[100:103], v[116:119], v[32:35]
  v_mfma_f32_16x16x32_bf16 v[36:39], v[100:103], v[120:123], v[36:39]
  v_mfma_f32_16x16x32_bf16 v[40:43], v[100:103], v[124:127], v[40:43]
  v_mfma_f32_16x16x32_bf16 v[44:47], v[100:103], v[128:131], v[44:47]
  buffer_load_dwordx4 v[100:103], v1, s[12:15], s31 offen offset:1024
  v_mfma_f32_16x16x32_bf16 v[48:51], v[104:107], v[116:119], v[48:51]
  v_mfma_f32_16x16x32_bf16 v[52:55], v[104:107], v[120:123], v[52:55]
  v_mfma_f32_16x16x32_bf16 v[56:59], v[104:107], v[124:127], v[56:59]
  v_mfma_f32_16x16x32_bf16 v[60:63], v[104:107], v[128:131], v[60:63]
  buffer_load_dwordx4 v[104:107], v1, s[12:15], s31 offen offset:2048
  v_mfma_f32_16x16x32_bf16 v[64:67], v[108:111], v[116:119], v[64:67]
  v_mfma_f32_16x16x32_bf16 v[68:71], v[108:111], v[120:123], v[68:71]
  v_mfma_f32_16x16x32_bf16 v[72:75], v[108:111], v[124:127], v[72:75]
  v_mfma_f32_16x16x32_bf16 v[76:79], v[108:111], v[128:131], v[76:79]
  buffer_load_dwordx4 v[108:111], v1, s[12:15], s31 offen offset:3072
  v_mfma_f32_16x16x32_bf16 v[80:83], v[112:115], v[116:119], v[80:83]
  v_mfma_f32_16x16x32_bf16 v[84:87], v[112:115], v[120:123], v[84:87]
  buffer_load_dwordx4 v[116:119], v1, s[12:15], s30 offen offset:0 sc1
  v_mfma_f32_16x16x32_bf16 v[88:91], v[112:115], v[124:127], v[88:91]
  buffer_load_dwordx4 v[120:123], v1, s[12:15], s30 offen offset:1024 sc1
  v_mfma_f32_16x16x32_bf16 v[92:95], v[112:115], v[128:131], v[92:95]
  buffer_load_dwordx4 v[124:127], v1, s[12:15], s30 offen offset:2048 sc1
  buffer_load_dwordx4 v[112:115], v2, s[12:15], s31 offen
  s_add_u32 s31, s31, 40960
  buffer_load_dwordx4 v[128:131], v1, s[12:15], s30 offen offset:3072 sc1
  s_add_u32 s30, s30, 4096
  s_waitcnt vmcnt(17)
  v_mfma_f32_16x16x32_bf16 v[16:19], v[132:135], v[152:155], v[16:19]
  v_mfma_f32_16x16x32_bf16 v[20:23], v[132:135], v[156:159], v[20:23]
  v_mfma_f32_16x16x32_bf16 v[24:27], v[132:135], v[160:163], v[24:27]
  v_mfma_f32_16x16x32_bf16 v[28:31], v[132:135], v[164:167], v[28:31]
  buffer_load_dwordx4 v[132:135], v1, s[12:15], s31 offen offset:0
  v_mfma_f32_16x16x32_bf16 v[32:35], v[136:139], v[152:155], v[32:35]
  v_mfma_f32_16x16x32_bf16 v[36:39], v[136:139], v[156:159], v[36:39]
  v_mfma_f32_16x16x32_bf16 v[40:43], v[136:139], v[160:163], v[40:43]
  v_mfma_f32_16x16x32_bf16 v[44:47], v[136:139], v[164:167], v[44:47]
  buffer_load_dwordx4 v[136:139], v1, s[12:15], s31 offen offset:1024
  v_mfma_f32_16x16x32_bf16 v[48:51], v[140:143], v[152:155], v[48:51]
  v_mfma_f32_16x16x32_bf16 v[52:55], v[140:143], v[156:159], v[52:55]
  v_mfma_f32_16x16x32_bf16 v[56:59], v[140:143], v[160:163], v[56:59]
  v_mfma_f32_16x16x32_bf16 v[60:63], v[140:143], v[164:167], v[60:63]
  buffer_load_dwordx4 v[140:143], v1, s[12:15], s31 offen offset:2048
  v_mfma_f32_16x16x32_bf16 v[64:67], v[144:147], v[152:155], v[64:67]
  v_mfma_f32_16x16x32_bf16 v[68:71], v[144:147], v[156:159], v[68:71]
  v_mfma_f32_16x16x32_bf16 v[72:75], v[144:147], v[160:163], v[72:75]
  v_mfma_f32_16x16x32_bf16 v[76:79], v[144:147], v[164:167], v[76:79]
  buffer_load_dwordx4 v[144:147], v1, s[12:15], s31 offen offset:3072
  v_mfma_f32_16x16x32_bf16 v[80:83], v[148:151], v[152:155], v[80:83]
  v_mfma_f32_16x16x32_bf16 v[84:87], v[148:151], v[156:159], v[84:87]
  buffer_load_dwordx4 v[152:155], v1, s[12:15], s30 offen offset:0 sc1
  v_mfma_f32_16x16x32_bf16 v[88:91], v[148:151], v[160:163], v[88:91]
  buffer_load_dwordx4 v[156:159], v1, s[12:15], s30 offen offset:1024 sc1
  v_mfma_f32_16x16x32_bf16 v[92:95], v[148:151], v[164:167], v[92:95]
  buffer_load_dwordx4 v[160:163], v1, s[12:15], s30 offen offset:2048 sc1
  buffer_load_dwordx4 v[148:151], v2, s[12:15], s31 offen
  s_add_u32 s31, s31, 40960
  buffer_load_dwordx4 v[164:167], v1, s[12:15], s30 offen offset:3072 sc1
  s_add_u32 s30, s30, 4096
  s_waitcnt vmcnt(22)
  v_mfma_f32_16x16x32_bf16 v[16:19], v[168:171], v[188:191], v[16:19]
  v_mfma_f32_16x16x32_bf16 v[20:23], v[168:171], v[192:195], v[20:23]
  v_mfma_f32_16x16x32_bf16 v[24:27], v[168:171], v[196:199], v[24:27]
  v_mfma_f32_16x16x32_bf16 v[28:31], v[168:171], v[200:203], v[28:31]
  buffer_load_dwordx4 v[168:171], v1, s[12:15], s31 offen offset:0
  v_mfma_f32_16x16x32_bf16 v[32:35], v[172:175], v[188:191], v[32:35]
  v_mfma_f32_16x16x32_bf16 v[36:39], v[172:175], v[192:195], v[36:39]
  v_mfma_f32_16x16x32_bf16 v[40:43], v[172:175], v[196:199], v[40:43]
  v_mfma_f32_16x16x32_bf16 v[44:47], v[172:175], v[200:203], v[44:47]
  buffer_load_dwordx4 v[172:175], v1, s[12:15], s31 offen offset:1024
  v_mfma_f32_16x16x32_bf16 v[48:51], v[176:179], v[188:191], v[48:51]
  v_mfma_f32_16x16x32_bf16 v[52:55], v[176:179], v[192:195], v[52:55]
  v_mfma_f32_16x16x32_bf16 v[56:59], v[176:179], v[196:199], v[56:59]
  v_mfma_f32_16x16x32_bf16 v[60:63], v[176:179], v[200:203], v[60:63]
  buffer_load_dwordx4 v[176:179], v1, s[12:15], s31 offen offset:2048
  v_mfma_f32_16x16x32_bf16 v[64:67], v[180:183], v[188:191], v[64:67]
  v_mfma_f32_16x16x32_bf16 v[68:71], v[180:183], v[192:195], v[68:71]
  v_mfma_f32_16x16x32_bf16 v[72:75], v[180:183], v[196:199], v[72:75]
  v_mfma_f32_16x16x32_bf16 v[76:79], v[180:183], v[200:203], v[76:79]
  buffer_load_dwordx4 v[180:183], v1, s[12:15], s31 offen offset:3072
  v_mfma_f32_16x16x32_bf16 v[80:83], v[184:187], v[188:191], v[80:83]
  v_mfma_f32_16x16x32_bf16 v[84:87], v[184:187], v[192:195], v[84:87]
  buffer_load_dwordx4 v[188:191], v1, s[12:15], s30 offen offset:0 sc1
  v_mfma_f32_16x16x32_bf16 v[88:91], v[184:187], v[196:199], v[88:91]
  buffer_load_dwordx4 v[192:195], v1, s[12:15], s30 offen offset:1024 sc1
  v_mfma_f32_16x16x32_bf16 v[92:95], v[184:187], v[200:203], v[92:95]
  buffer_load_dwordx4 v[196:199], v1, s[12:15], s30 offen offset:2048 sc1
  buffer_load_dwordx4 v[184:187], v2, s[12:15], s31 offen
  s_add_u32 s31, s31, 40960
  buffer_load_dwordx4 v[200:203], v1, s[12:15], s30 offen offset:3072 sc1
  s_add_u32 s30, s30, 4096
  s_waitcnt vmcnt(27)
  v_mfma_f32_16x16x32_bf16 v[16:19], v[204:207], v[224:227], v[16:19]
  v_mfma_f32_16x16x32_bf16 v[20:23], v[204:207], v[228:231], v[20:23]
  v_mfma_f32_16x16x32_bf16 v[24:27], v[204:207], v[232:235], v[24:27]
  v_mfma_f32_16x16x32_bf16 v[28:31], v[204:207], v[236:239], v[28:31]
  buffer_load_dwordx4 v[204:207], v1, s[12:15], s31 offen offset:0
  v_mfma_f32_16x16x32_bf16 v[32:35], v[208:211], v[224:227], v[32:35]
  v_mfma_f32_16x16x32_bf16 v[36:39], v[208:211], v[228:231], v[36:39]
  v_mfma_f32_16x16x32_bf16 v[40:43], v[208:211], v[232:235], v[40:43]
  v_mfma_f32_16x16x32_bf16 v[44:47], v[208:211], v[236:239], v[44:47]
  buffer_load_dwordx4 v[208:211], v1, s[12:15], s31 offen offset:1024
  v_mfma_f32_16x16x32_bf16 v[48:51], v[212:215], v[224:227], v[48:51]
  v_mfma_f32_16x16x32_bf16 v[52:55], v[212:215], v[228:231], v[52:55]
  v_mfma_f32_16x16x32_bf16 v[56:59], v[212:215], v[232:235], v[56:59]
  v_mfma_f32_16x16x32_bf16 v[60:63], v[212:215], v[236:239], v[60:63]
  buffer_load_dwordx4 v[212:215], v1, s[12:15], s31 offen offset:2048
  v_mfma_f32_16x16x32_bf16 v[64:67], v[216:219], v[224:227], v[64:67]
  v_mfma_f32_16x16x32_bf16 v[68:71], v[216:219], v[228:231], v[68:71]
  v_mfma_f32_16x16x32_bf16 v[72:75], v[216:219], v[232:235], v[72:75]
  v_mfma_f32_16x16x32_bf16 v[76:79], v[216:219], v[236:239], v[76:79]
  buffer_load_dwordx4 v[216:219], v1, s[12:15], s31 offen offset:3072
  v_mfma_f32_16x16x32_bf16 v[80:83], v[220:223], v[224:227], v[80:83]
  v_mfma_f32_16x16x32_bf16 v[84:87], v[220:223], v[228:231], v[84:87]
  buffer_load_dwordx4 v[224:227], v1, s[12:15], s30 offen offset:0 sc1
  v_mfma_f32_16x16x32_bf16 v[88:91], v[220:223], v[232:235], v[88:91]
  buffer_load_dwordx4 v[228:231], v1, s[12:15], s30 offen offset:1024 sc1
  v_mfma_f32_16x16x32_bf16 v[92:95], v[220:223], v[236:239], v[92:95]
  buffer_load_dwordx4 v[232:235], v1, s[12:15], s30 offen offset:2048 sc1
  buffer_load_dwordx4 v[220:223], v2, s[12:15], s31 offen
  s_add_u32 s31, s31, 40960
  buffer_load_dwordx4 v[236:239], v1, s[12:15], s30 offen offset:3072 sc1
  s_add_u32 s30, s30, 4096
  s_waitcnt vmcnt(27)
  v_mfma_f32_16x16x32_bf16 v[16:19], v[96:99], v[116:119], v[16:19]
  v_mfma_f32_16x16x32_bf16 v[20:23], v[96:99], v[120:123], v[20:23]
  v_mfma_f32_16x16x32_bf16 v[24:27], v[96:99], v[124:127], v[24:27]
  v_mfma_f32_16x16x32_bf16 v[28:31], v[96:99], v[128:131], v[28:31]
  buffer_load_dwordx4 v[96:99], v1, s[12:15], s31 offen offset:0
  v_mfma_f32_16x16x32_bf16 v[32:35], v[100:103], v[116:119], v[32:35]
  v_mfma_f32_16x16x32_bf16 v[36:39], v[100:103], v[120:123], v[36:39]
  v_mfma_f32_16x16x32_bf16 v[40:43], v[100:103], v[124:127], v[40:43]
  v_mfma_f32_16x16x32_bf16 v[44:47], v[100:103], v[128:131], v[44:47]
  buffer_load_dwordx4 v[100:103], v1, s[12:15], s31 offen offset:1024
  v_mfma_f32_16x16x32_bf16 v[48:51], v[104:107], v[116:119], v[48:51]
  v_mfma_f32_16x16x32_bf16 v[52:55], v[104:107], v[120:123], v[52:55]
  v_mfma_f32_16x16x32_bf16 v[56:59], v[104:107], v[124:127], v[56:59]
  v_mfma_f32_16x16x32_bf16 v[60:63], v[104:107], v[128:131], v[60:63]
  buffer_load_dwordx4 v[104:107], v1, s[12:15], s31 offen offset:2048
  v_mfma_f32_16x16x32_bf16 v[64:67], v[108:111], v[116:119], v[64:67]
  v_mfma_f32_16x16x32_bf16 v[68:71], v[108:111], v[120:123], v[68:71]
  v_mfma_f32_16x16x32_bf16 v[72:75], v[108:111], v[124:127], v[72:75]
  v_mfma_f32_16x16x32_bf16 v[76:79], v[108:111], v[128:131], v[76:79]
  buffer_load_dwordx4 v[108:111], v1, s[12:15], s31 offen offset:3072
  v_mfma_f32_16x16x32_bf16 v[80:83], v[112:115], v[116:119], v[80:83]
  v_mfma_f32_16x16x32_bf16 v[84:87], v[112:115], v[120:123], v[84:87]
  buffer_load_dwordx4 v[116:119], v1, s[12:15], s30 offen offset:0 sc1
  v_mfma_f32_16x16x32_bf16 v[88:91], v[112:115], v[124:127], v[88:91]
  buffer_load_dwordx4 v[120:123], v1, s[12:15], s30 offen offset:1024 sc1
  v_mfma_f32_16x16x32_bf16 v[92:95], v[112:115], v[128:131], v[92:95]
  buffer_load_dwordx4 v[124:127], v1, s[12:15], s30 offen offset:2048 sc1
  buffer_load_dwordx4 v[112:115], v2, s[12:15], s31 offen
  s_add_u32 s31, s31, 40960
  buffer_load_dwordx4 v[128:131], v1, s[12:15], s30 offen offset:3072 sc1
  s_add_u32 s30, s30, 4096
  s_waitcnt vmcnt(27)
  v_mfma_f32_16x16x32_bf16 v[16:19], v[132:135], v[152:155], v[16:19]
  v_mfma_f32_16x16x32_bf16 v[20:23], v[132:135], v[156:159], v[20:23]
  v_mfma_f32_16x16x32_bf16 v[24:27], v[132:135], v[160:163], v[24:27]
  v_mfma_f32_16x16x32_bf16 v[28:31], v[132:135], v[164:167], v[28:31]
  buffer_load_dwordx4 v[132:135], v1, s[12:15], s31 offen offset:0
  v_mfma_f32_16x16x32_bf16 v[32:35], v[136:139], v[152:155], v[32:35]
  v_mfma_f32_16x16x32_bf16 v[36:39], v[136:139], v[156:159], v[36:39]
  v_mfma_f32_16x16x32_bf16 v[40:43], v[136:139], v[160:163], v[40:43]
  v_mfma_f32_16x16x32_bf16 v[44:47], v[136:139], v[164:167], v[44:47]
  buffer_load_dwordx4 v[136:139], v1, s[12:15], s31 offen offset:1024
  v_mfma_f32_16x16x32_bf16 v[48:51], v[140:143], v[152:155], v[48:51]
  v_mfma_f32_16x16x32_bf16 v[52:55], v[140:143], v[156:159], v[52:55]
  v_mfma_f32_16x16x32_bf16 v[56:59], v[140:143], v[160:163], v[56:59]
  v_mfma_f32_16x16x32_bf16 v[60:63], v[140:143], v[164:167], v[60:63]
  buffer_load_dwordx4 v[140:143], v1, s[12:15], s31 offen offset:2048
  v_mfma_f32_16x16x32_bf16 v[64:67], v[144:147], v[152:155], v[64:67]
  v_mfma_f32_16x16x32_bf16 v[68:71], v[144:147], v[156:159], v[68:71]
  v_mfma_f32_16x16x32_bf16 v[72:75], v[144:147], v[160:163], v[72:75]
  v_mfma_f32_16x16x32_bf16 v[76:79], v[144:147], v[164:167], v[76:79]
  buffer_load_dwordx4 v[144:147], v1, s[12:15], s31 offen offset:3072
  v_mfma_f32_16x16x32_bf16 v[80:83], v[148:151], v[152:155], v[80:83]
  v_mfma_f32_16x16x32_bf16 v[84:87], v[148:151], v[156:159], v[84:87]
  buffer_load_dwordx4 v[152:155], v1, s[12:15], s30 offen offset:0 sc1
  v_mfma_f32_16x16x32_bf16 v[88:91], v[148:151], v[160:163], v[88:91]
  buffer_load_dwordx4 v[156:159], v1, s[12:15], s30 offen offset:1024 sc1
  v_mfma_f32_16x16x32_bf16 v[92:95], v[148:151], v[164:167], v[92:95]
  buffer_load_dwordx4 v[160:163], v1, s[12:15], s30 offen offset:2048 sc1
  buffer_load_dwordx4 v[148:151], v2, s[12:15], s31 offen
  s_add_u32 s31, s31, 40960
  buffer_load_dwordx4 v[164:167], v1, s[12:15], s30 offen offset:3072 sc1
  s_add_u32 s30, s30, 4096
  s_waitcnt vmcnt(27)
  v_mfma_f32_16x16x32_bf16 v[16:19], v[168:171], v[188:191], v[16:19]
  v_mfma_f32_16x16x32_bf16 v[20:23], v[168:171], v[192:195], v[20:23]
  v_mfma_f32_16x16x32_bf16 v[24:27], v[168:171], v[196:199], v[24:27]
  v_mfma_f32_16x16x32_bf16 v[28:31], v[168:171], v[200:203], v[28:31]
  buffer_load_dwordx4 v[168:171], v1, s[12:15], s31 offen offset:0
  v_mfma_f32_16x16x32_bf16 v[32:35], v[172:175], v[188:191], v[32:35]
  v_mfma_f32_16x16x32_bf16 v[36:39], v[172:175], v[192:195], v[36:39]
  v_mfma_f32_16x16x32_bf16 v[40:43], v[172:175], v[196:199], v[40:43]
  v_mfma_f32_16x16x32_bf16 v[44:47], v[172:175], v[200:203], v[44:47]
  buffer_load_dwordx4 v[172:175], v1, s[12:15], s31 offen offset:1024
  v_mfma_f32_16x16x32_bf16 v[48:51], v[176:179], v[188:191], v[48:51]
  v_mfma_f32_16x16x32_bf16 v[52:55], v[176:179], v[192:195], v[52:55]
  v_mfma_f32_16x16x32_bf16 v[56:59], v[176:179], v[196:199], v[56:59]
  v_mfma_f32_16x16x32_bf16 v[60:63], v[176:179], v[200:203], v[60:63]
  buffer_load_dwordx4 v[176:179], v1, s[12:15], s31 offen offset:2048
  v_mfma_f32_16x16x32_bf16 v[64:67], v[180:183], v[188:191], v[64:67]
  v_mfma_f32_16x16x32_bf16 v[68:71], v[180:183], v[192:195], v[68:71]
  v_mfma_f32_16x16x32_bf16 v[72:75], v[180:183], v[196:199], v[72:75]
  v_mfma_f32_16x16x32_bf16 v[76:79], v[180:183], v[200:203], v[76:79]
  buffer_load_dwordx4 v[180:183], v1, s[12:15], s31 offen offset:3072
  v_mfma_f32_16x16x32_bf16 v[80:83], v[184:187], v[188:191], v[80:83]
  v_mfma_f32_16x16x32_bf16 v[84:87], v[184:187], v[192:195], v[84:87]
  buffer_load_dwordx4 v[188:191], v1, s[12:15], s30 offen offset:0 sc1
  v_mfma_f32_16x16x32_bf16 v[88:91], v[184:187], v[196:199], v[88:91]
  buffer_load_dwordx4 v[192:195], v1, s[12:15], s30 offen offset:1024 sc1
  v_mfma_f32_16x16x32_bf16 v[92:95], v[184:187], v[200:203], v[92:95]
  buffer_load_dwordx4 v[196:199], v1, s[12:15], s30 offen offset:2048 sc1
  buffer_load_dwordx4 v[184:187], v2, s[12:15], s31 offen
  s_add_u32 s31, s31, 40960
  buffer_load_dwordx4 v[200:203], v1, s[12:15], s30 offen offset:3072 sc1
  s_add_u32 s30, s30, 4096
  s_waitcnt vmcnt(27)
  v_mfma_f32_16x16x32_bf16 v[16:19], v[204:207], v[224:227], v[16:19]
  v_mfma_f32_16x16x32_bf16 v[20:23], v[204:207], v[228:231], v[20:23]
  v_mfma_f32_16x16x32_bf16 v[24:27], v[204:207], v[232:235], v[24:27]
  v_mfma_f32_16x16x32_bf16 v[28:31], v[204:207], v[236:239], v[28:31]
  buffer_load_dwordx4 v[204:207], v1, s[12:15], s31 offen offset:0
  v_mfma_f32_16x16x32_bf16 v[32:35], v[208:211], v[224:227], v[32:35]
  v_mfma_f32_16x16x32_bf16 v[36:39], v[208:211], v[228:231], v[36:39]
  v_mfma_f32_16x16x32_bf16 v[40:43], v[208:211], v[232:235], v[40:43]
  v_mfma_f32_16x16x32_bf16 v[44:47], v[208:211], v[236:239], v[44:47]
  buffer_load_dwordx4 v[208:211], v1, s[12:15], s31 offen offset:1024
  v_mfma_f32_16x16x32_bf16 v[48:51], v[212:215], v[224:227], v[48:51]
  v_mfma_f32_16x16x32_bf16 v[52:55], v[212:215], v[228:231], v[52:55]
  v_mfma_f32_16x16x32_bf16 v[56:59], v[212:215], v[232:235], v[56:59]
  v_mfma_f32_16x16x32_bf16 v[60:63], v[212:215], v[236:239], v[60:63]
  buffer_load_dwordx4 v[212:215], v1, s[12:15], s31 offen offset:2048
  v_mfma_f32_16x16x32_bf16 v[64:67], v[216:219], v[224:227], v[64:67]
  v_mfma_f32_16x16x32_bf16 v[68:71], v[216:219], v[228:231], v[68:71]
  v_mfma_f32_16x16x32_bf16 v[72:75], v[216:219], v[232:235], v[72:75]
  v_mfma_f32_16x16x32_bf16 v[76:79], v[216:219], v[236:239], v[76:79]
  buffer_load_dwordx4 v[216:219], v1, s[12:15], s31 offen offset:3072
  v_mfma_f32_16x16x32_bf16 v[80:83], v[220:223], v[224:227], v[80:83]
  v_mfma_f32_16x16x32_bf16 v[84:87], v[220:223], v[228:231], v[84:87]
  buffer_load_dwordx4 v[224:227], v1, s[12:15], s30 offen offset:0 sc1
  v_mfma_f32_16x16x32_bf16 v[88:91], v[220:223], v[232:235], v[88:91]
  buffer_load_dwordx4 v[228:231], v1, s[12:15], s30 offen offset:1024 sc1
  v_mfma_f32_16x16x32_bf16 v[92:95], v[220:223], v[236:239], v[92:95]
  buffer_load_dwordx4 v[232:235], v1, s[12:15], s30 offen offset:2048 sc1
  buffer_load_dwordx4 v[220:223], v2, s[12:15], s31 offen
  s_add_u32 s31, s31, 40960
  buffer_load_dwordx4 v[236:239], v1, s[12:15], s30 offen offset:3072 sc1
  s_add_u32 s30, s30, 4096
  s_waitcnt vmcnt(27)
  v_mfma_f32_16x16x32_bf16 v[16:19], v[96:99], v[116:119], v[16:19]
  v_mfma_f32_16x16x32_bf16 v[20:23], v[96:99], v[120:123], v[20:23]
  v_mfma_f32_16x16x32_bf16 v[24:27], v[96:99], v[124:127], v[24:27]
  v_mfma_f32_16x16x32_bf16 v[28:31], v[96:99], v[128:131], v[28:31]
  buffer_load_dwordx4 v[96:99], v1, s[12:15], s31 offen offset:0
  v_mfma_f32_16x16x32_bf16 v[32:35], v[100:103], v[116:119], v[32:35]
  v_mfma_f32_16x16x32_bf16 v[36:39], v[100:103], v[120:123], v[36:39]
  v_mfma_f32_16x16x32_bf16 v[40:43], v[100:103], v[124:127], v[40:43]
  v_mfma_f32_16x16x32_bf16 v[44:47], v[100:103], v[128:131], v[44:47]
  buffer_load_dwordx4 v[100:103], v1, s[12:15], s31 offen offset:1024
  v_mfma_f32_16x16x32_bf16 v[48:51], v[104:107], v[116:119], v[48:51]
  v_mfma_f32_16x16x32_bf16 v[52:55], v[104:107], v[120:123], v[52:55]
  v_mfma_f32_16x16x32_bf16 v[56:59], v[104:107], v[124:127], v[56:59]
  v_mfma_f32_16x16x32_bf16 v[60:63], v[104:107], v[128:131], v[60:63]
  buffer_load_dwordx4 v[104:107], v1, s[12:15], s31 offen offset:2048
  v_mfma_f32_16x16x32_bf16 v[64:67], v[108:111], v[116:119], v[64:67]
  v_mfma_f32_16x16x32_bf16 v[68:71], v[108:111], v[120:123], v[68:71]
  v_mfma_f32_16x16x32_bf16 v[72:75], v[108:111], v[124:127], v[72:75]
  v_mfma_f32_16x16x32_bf16 v[76:79], v[108:111], v[128:131], v[76:79]
  buffer_load_dwordx4 v[108:111], v1, s[12:15], s31 offen offset:3072
  v_mfma_f32_16x16x32_bf16 v[80:83], v[112:115], v[116:119], v[80:83]
  v_mfma_f32_16x16x32_bf16 v[84:87], v[112:115], v[120:123], v[84:87]
  buffer_load_dwordx4 v[116:119], v1, s[12:15], s30 offen offset:0 sc1
  v_mfma_f32_16x16x32_bf16 v[88:91], v[112:115], v[124:127], v[88:91]
  buffer_load_dwordx4 v[120:123], v1, s[12:15], s30 offen offset:1024 sc1
  v_mfma_f32_16x16x32_bf16 v[92:95], v[112:115], v[128:131], v[92:95]
  buffer_load_dwordx4 v[124:127], v1, s[12:15], s30 offen offset:2048 sc1
  buffer_load_dwordx4 v[112:115], v2, s[12:15], s31 offen
  s_add_u32 s31, s31, 40960
  buffer_load_dwordx4 v[128:131], v1, s[12:15], s30 offen offset:3072 sc1
  s_add_u32 s30, s30, 4096
  s_waitcnt vmcnt(27)
  v_mfma_f32_16x16x32_bf16 v[16:19], v[132:135], v[152:155], v[16:19]
  v_mfma_f32_16x16x32_bf16 v[20:23], v[132:135], v[156:159], v[20:23]
  v_mfma_f32_16x16x32_bf16 v[24:27], v[132:135], v[160:163], v[24:27]
  v_mfma_f32_16x16x32_bf16 v[28:31], v[132:135], v[164:167], v[28:31]
  buffer_load_dwordx4 v[132:135], v1, s[12:15], s31 offen offset:0
  v_mfma_f32_16x16x32_bf16 v[32:35], v[136:139], v[152:155], v[32:35]
  v_mfma_f32_16x16x32_bf16 v[36:39], v[136:139], v[156:159], v[36:39]
  v_mfma_f32_16x16x32_bf16 v[40:43], v[136:139], v[160:163], v[40:43]
  v_mfma_f32_16x16x32_bf16 v[44:47], v[136:139], v[164:167], v[44:47]
  buffer_load_dwordx4 v[136:139], v1, s[12:15], s31 offen offset:1024
  v_mfma_f32_16x16x32_bf16 v[48:51], v[140:143], v[152:155], v[48:51]
  v_mfma_f32_16x16x32_bf16 v[52:55], v[140:143], v[156:159], v[52:55]
  v_mfma_f32_16x16x32_bf16 v[56:59], v[140:143], v[160:163], v[56:59]
  v_mfma_f32_16x16x32_bf16 v[60:63], v[140:143], v[164:167], v[60:63]
  buffer_load_dwordx4 v[140:143], v1, s[12:15], s31 offen offset:2048
  v_mfma_f32_16x16x32_bf16 v[64:67], v[144:147], v[152:155], v[64:67]
  v_mfma_f32_16x16x32_bf16 v[68:71], v[144:147], v[156:159], v[68:71]
  v_mfma_f32_16x16x32_bf16 v[72:75], v[144:147], v[160:163], v[72:75]
  v_mfma_f32_16x16x32_bf16 v[76:79], v[144:147], v[164:167], v[76:79]
  buffer_load_dwordx4 v[144:147], v1, s[12:15], s31 offen offset:3072
  v_mfma_f32_16x16x32_bf16 v[80:83], v[148:151], v[152:155], v[80:83]
  v_mfma_f32_16x16x32_bf16 v[84:87], v[148:151], v[156:159], v[84:87]
  buffer_load_dwordx4 v[152:155], v1, s[12:15], s30 offen offset:0 sc1
  v_mfma_f32_16x16x32_bf16 v[88:91], v[148:151], v[160:163], v[88:91]
  buffer_load_dwordx4 v[156:159], v1, s[12:15], s30 offen offset:1024 sc1
  v_mfma_f32_16x16x32_bf16 v[92:95], v[148:151], v[164:167], v[92:95]
  buffer_load_dwordx4 v[160:163], v1, s[12:15], s30 offen offset:2048 sc1
  buffer_load_dwordx4 v[148:151], v2, s[12:15], s31 offen
  s_add_u32 s31, s31, 40960
  buffer_load_dwordx4 v[164:167], v1, s[12:15], s30 offen offset:3072 sc1
  s_add_u32 s30, s30, 4096
  s_waitcnt vmcnt(27)
  v_mfma_f32_16x16x32_bf16 v[16:19], v[168:171], v[188:191], v[16:19]
  v_mfma_f32_16x16x32_bf16 v[20:23], v[168:171], v[192:195], v[20:23]
  v_mfma_f32_16x16x32_bf16 v[24:27], v[168:171], v[196:199], v[24:27]
  v_mfma_f32_16x16x32_bf16 v[28:31], v[168:171], v[200:203], v[28:31]
  buffer_load_dwordx4 v[168:171], v1, s[12:15], s31 offen offset:0
  v_mfma_f32_16x16x32_bf16 v[32:35], v[172:175], v[188:191], v[32:35]
  v_mfma_f32_16x16x32_bf16 v[36:39], v[172:175], v[192:195], v[36:39]
  v_mfma_f32_16x16x32_bf16 v[40:43], v[172:175], v[196:199], v[40:43]
  v_mfma_f32_16x16x32_bf16 v[44:47], v[172:175], v[200:203], v[44:47]
  buffer_load_dwordx4 v[172:175], v1, s[12:15], s31 offen offset:1024
  v_mfma_f32_16x16x32_bf16 v[48:51], v[176:179], v[188:191], v[48:51]
  v_mfma_f32_16x16x32_bf16 v[52:55], v[176:179], v[192:195], v[52:55]
  v_mfma_f32_16x16x32_bf16 v[56:59], v[176:179], v[196:199], v[56:59]
  v_mfma_f32_16x16x32_bf16 v[60:63], v[176:179], v[200:203], v[60:63]
  buffer_load_dwordx4 v[176:179], v1, s[12:15], s31 offen offset:2048
  v_mfma_f32_16x16x32_bf16 v[64:67], v[180:183], v[188:191], v[64:67]
  v_mfma_f32_16x16x32_bf16 v[68:71], v[180:183], v[192:195], v[68:71]
  v_mfma_f32_16x16x32_bf16 v[72:75], v[180:183], v[196:199], v[72:75]
  v_mfma_f32_16x16x32_bf16 v[76:79], v[180:183], v[200:203], v[76:79]
  buffer_load_dwordx4 v[180:183], v1, s[12:15], s31 offen offset:3072
  v_mfma_f32_16x16x32_bf16 v[80:83], v[184:187], v[188:191], v[80:83]
  v_mfma_f32_16x16x32_bf16 v[84:87], v[184:187], v[192:195], v[84:87]
  buffer_load_dwordx4 v[188:191], v1, s[12:15], s30 offen offset:0 sc1
  v_mfma_f32_16x16x32_bf16 v[88:91], v[184:187], v[196:199], v[88:91]
  buffer_load_dwordx4 v[192:195], v1, s[12:15], s30 offen offset:1024 sc1
  v_mfma_f32_16x16x32_bf16 v[92:95], v[184:187], v[200:203], v[92:95]
  buffer_load_dwordx4 v[196:199], v1, s[12:15], s30 offen offset:2048 sc1
  buffer_load_dwordx4 v[184:187], v2, s[12:15], s31 offen
  s_add_u32 s31, s31, 40960
  buffer_load_dwordx4 v[200:203], v1, s[12:15], s30 offen offset:3072 sc1
  s_add_u32 s30, s30, 4096
  s_cmp_eq_u32 s24, 0
  s_cbranch_scc0 K2_NOTRIG
  v_mov_b32 v4, 112640
  v_mov_b32 v5, 1
  ds_write_b32 v4, v5 offset:32
K2_NOTRIG:
  s_waitcnt vmcnt(27)
  v_mfma_f32_16x16x32_bf16 v[16:19], v[204:207], v[224:227], v[16:19]
  v_mfma_f32_16x16x32_bf16 v[20:23], v[204:207], v[228:231], v[20:23]
  v_mfma_f32_16x16x32_bf16 v[24:27], v[204:207], v[232:235], v[24:27]
  v_mfma_f32_16x16x32_bf16 v[28:31], v[204:207], v[236:239], v[28:31]
  buffer_load_dwordx4 v[204:207], v1, s[12:15], s31 offen offset:0
  v_mfma_f32_16x16x32_bf16 v[32:35], v[208:211], v[224:227], v[32:35]
  v_mfma_f32_16x16x32_bf16 v[36:39], v[208:211], v[228:231], v[36:39]
  v_mfma_f32_16x16x32_bf16 v[40:43], v[208:211], v[232:235], v[40:43]
  v_mfma_f32_16x16x32_bf16 v[44:47], v[208:211], v[236:239], v[44:47]
  buffer_load_dwordx4 v[208:211], v1, s[12:15], s31 offen offset:1024
  v_mfma_f32_16x16x32_bf16 v[48:51], v[212:215], v[224:227], v[48:51]
  v_mfma_f32_16x16x32_bf16 v[52:55], v[212:215], v[228:231], v[52:55]
  v_mfma_f32_16x16x32_bf16 v[56:59], v[212:215], v[232:235], v[56:59]
  v_mfma_f32_16x16x32_bf16 v[60:63], v[212:215], v[236:239], v[60:63]
  buffer_load_dwordx4 v[212:215], v1, s[12:15], s31 offen offset:2048
  v_mfma_f32_16x16x32_bf16 v[64:67], v[216:219], v[224:227], v[64:67]
  v_mfma_f32_16x16x32_bf16 v[68:71], v[216:219], v[228:231], v[68:71]
  v_mfma_f32_16x16x32_bf16 v[72:75], v[216:219], v[232:235], v[72:75]
  v_mfma_f32_16x16x32_bf16 v[76:79], v[216:219], v[236:239], v[76:79]
  buffer_load_dwordx4 v[216:219], v1, s[12:15], s31 offen offset:3072
  v_mfma_f32_16x16x32_bf16 v[80:83], v[220:223], v[224:227], v[80:83]
  v_mfma_f32_16x16x32_bf16 v[84:87], v[220:223], v[228:231], v[84:87]
  v_mfma_f32_16x16x32_bf16 v[88:91], v[220:223], v[232:235], v[88:91]
  v_mfma_f32_16x16x32_bf16 v[92:95], v[220:223], v[236:239], v[92:95]
  buffer_load_dwordx4 v[220:223], v2, s[12:15], s31 offen
  s_add_u32 s31, s31, 40960
  s_waitcnt vmcnt(23)
  v_mfma_f32_16x16x32_bf16 v[16:19], v[96:99], v[116:119], v[16:19]
  v_mfma_f32_16x16x32_bf16 v[20:23], v[96:99], v[120:123], v[20:23]
  v_mfma_f32_16x16x32_bf16 v[24:27], v[96:99], v[124:127], v[24:27]
  v_mfma_f32_16x16x32_bf16 v[28:31], v[96:99], v[128:131], v[28:31]
  buffer_load_dwordx4 v[96:99], v1, s[12:15], s31 offen offset:0
  v_mfma_f32_16x16x32_bf16 v[32:35], v[100:103], v[116:119], v[32:35]
  v_mfma_f32_16x16x32_bf16 v[36:39], v[100:103], v[120:123], v[36:39]
  v_mfma_f32_16x16x32_bf16 v[40:43], v[100:103], v[124:127], v[40:43]
  v_mfma_f32_16x16x32_bf16 v[44:47], v[100:103], v[128:131], v[44:47]
  buffer_load_dwordx4 v[100:103], v1, s[12:15], s31 offen offset:1024
  v_mfma_f32_16x16x32_bf16 v[48:51], v[104:107], v[116:119], v[48:51]
  v_mfma_f32_16x16x32_bf16 v[52:55], v[104:107], v[120:123], v[52:55]
  v_mfma_f32_16x16x32_bf16 v[56:59], v[104:107], v[124:127], v[56:59]
  v_mfma_f32_16x16x32_bf16 v[60:63], v[104:107], v[128:131], v[60:63]
  buffer_load_dwordx4 v[104:107], v1, s[12:15], s31 offen offset:2048
  v_mfma_f32_16x16x32_bf16 v[64:67], v[108:111], v[116:119], v[64:67]
  v_mfma_f32_16x16x32_bf16 v[68:71], v[108:111], v[120:123], v[68:71]
  v_mfma_f32_16x16x32_bf16 v[72:75], v[108:111], v[124:127], v[72:75]
  v_mfma_f32_16x16x32_bf16 v[76:79], v[108:111], v[128:131], v[76:79]
  buffer_load_dwordx4 v[108:111], v1, s[12:15], s31 offen offset:3072
  v_mfma_f32_16x16x32_bf16 v[80:83], v[112:115], v[116:119], v[80:83]
  v_mfma_f32_16x16x32_bf16 v[84:87], v[112:115], v[120:123], v[84:87]
  v_mfma_f32_16x16x32_bf16 v[88:91], v[112:115], v[124:127], v[88:91]
  v_mfma_f32_16x16x32_bf16 v[92:95], v[112:115], v[128:131], v[92:95]
  buffer_load_dwordx4 v[112:115], v2, s[12:15], s31 offen
  s_add_u32 s31, s31, 40960
  s_waitcnt vmcnt(19)
  v_mfma_f32_16x16x32_bf16 v[16:19], v[132:135], v[152:155], v[16:19]
  v_mfma_f32_16x16x32_bf16 v[20:23], v[132:135], v[156:159], v[20:23]
  v_mfma_f32_16x16x32_bf16 v[24:27], v[132:135], v[160:163], v[24:27]
  v_mfma_f32_16x16x32_bf16 v[28:31], v[132:135], v[164:167], v[28:31]
  buffer_load_dwordx4 v[132:135], v1, s[12:15], s31 offen offset:0
  v_mfma_f32_16x16x32_bf16 v[32:35], v[136:139], v[152:155], v[32:35]
  v_mfma_f32_16x16x32_bf16 v[36:39], v[136:139], v[156:159], v[36:39]
  v_mfma_f32_16x16x32_bf16 v[40:43], v[136:139], v[160:163], v[40:43]
  v_mfma_f32_16x16x32_bf16 v[44:47], v[136:139], v[164:167], v[44:47]
  buffer_load_dwordx4 v[136:139], v1, s[12:15], s31 offen offset:1024
  v_mfma_f32_16x16x32_bf16 v[48:51], v[140:143], v[152:155], v[48:51]
  v_mfma_f32_16x16x32_bf16 v[52:55], v[140:143], v[156:159], v[52:55]
  v_mfma_f32_16x16x32_bf16 v[56:59], v[140:143], v[160:163], v[56:59]
  v_mfma_f32_16x16x32_bf16 v[60:63], v[140:143], v[164:167], v[60:63]
  buffer_load_dwordx4 v[140:143], v1, s[12:15], s31 offen offset:2048
  v_mfma_f32_16x16x32_bf16 v[64:67], v[144:147], v[152:155], v[64:67]
  v_mfma_f32_16x16x32_bf16 v[68:71], v[144:147], v[156:159], v[68:71]
  v_mfma_f32_16x16x32_bf16 v[72:75], v[144:147], v[160:163], v[72:75]
  v_mfma_f32_16x16x32_bf16 v[76:79], v[144:147], v[164:167], v[76:79]
  buffer_load_dwordx4 v[144:147], v1, s[12:15], s31 offen offset:3072
  v_mfma_f32_16x16x32_bf16 v[80:83], v[148:151], v[152:155], v[80:83]
  v_mfma_f32_16x16x32_bf16 v[84:87], v[148:151], v[156:159], v[84:87]
  v_mfma_f32_16x16x32_bf16 v[88:91], v[148:151], v[160:163], v[88:91]
  v_mfma_f32_16x16x32_bf16 v[92:95], v[148:151], v[164:167], v[92:95]
  buffer_load_dwordx4 v[148:151], v2, s[12:15], s31 offen
  s_add_u32 s31, s31, 40960
  s_waitcnt vmcnt(15)
  v_mfma_f32_16x16x32_bf16 v[16:19], v[168:171], v[188:191], v[16:19]
  v_mfma_f32_16x16x32_bf16 v[20:23], v[168:171], v[192:195], v[20:23]
  v_mfma_f32_16x16x32_bf16 v[24:27], v[168:171], v[196:199], v[24:27]
  v_mfma_f32_16x16x32_bf16 v[28:31], v[168:171], v[200:203], v[28:31]
  buffer_load_dwordx4 v[168:171], v1, s[12:15], s31 offen offset:0
  v_mfma_f32_16x16x32_bf16 v[32:35], v[172:175], v[188:191], v[32:35]
  v_mfma_f32_16x16x32_bf16 v[36:39], v[172:175], v[192:195], v[36:39]
  v_mfma_f32_16x16x32_bf16 v[40:43], v[172:175], v[196:199], v[40:43]
  v_mfma_f32_16x16x32_bf16 v[44:47], v[172:175], v[200:203], v[44:47]
  buffer_load_dwordx4 v[172:175], v1, s[12:15], s31 offen offset:1024
  v_mfma_f32_16x16x32_bf16 v[48:51], v[176:179], v[188:191], v[48:51]
  v_mfma_f32_16x16x32_bf16 v[52:55], v[176:179], v[192:195], v[52:55]
  v_mfma_f32_16x16x32_bf16 v[56:59], v[176:179], v[196:199], v[56:59]
  v_mfma_f32_16x16x32_bf16 v[60:63], v[176:179], v[200:203], v[60:63]
  buffer_load_dwordx4 v[176:179], v1, s[12:15], s31 offen offset:2048
  v_mfma_f32_16x16x32_bf16 v[64:67], v[180:183], v[188:191], v[64:67]
  v_mfma_f32_16x16x32_bf16 v[68:71], v[180:183], v[192:195], v[68:71]
  v_mfma_f32_16x16x32_bf16 v[72:75], v[180:183], v[196:199], v[72:75]
  v_mfma_f32_16x16x32_bf16 v[76:79], v[180:183], v[200:203], v[76:79]
  buffer_load_dwordx4 v[180:183], v1, s[12:15], s31 offen offset:3072
  v_mfma_f32_16x16x32_bf16 v[80:83], v[184:187], v[188:191], v[80:83]
  v_mfma_f32_16x16x32_bf16 v[84:87], v[184:187], v[192:195], v[84:87]
  v_mfma_f32_16x16x32_bf16 v[88:91], v[184:187], v[196:199], v[88:91]
  v_mfma_f32_16x16x32_bf16 v[92:95], v[184:187], v[200:203], v[92:95]
  buffer_load_dwordx4 v[184:187], v2, s[12:15], s31 offen
  s_add_u32 s31, s31, 40960
  v_mov_b32 v4, 112640
  s_mov_b32 s39, 8388608
K2_OWAIT:
  ds_read_b32 v5, v4 offset:4
  s_waitcnt lgkmcnt(0)
  v_readfirstlane_b32 s40, v5
  s_sub_u32 s39, s39, 1
  s_cmp_eq_u32 s39, 0
  s_cbranch_scc1 K2_OWAIT_X
  s_nop 0
  s_cmp_eq_u32 s40, 0
  s_cbranch_scc0 K2_OWAIT_X
  s_sleep 1
  s_branch K2_OWAIT
K2_OWAIT_X:
  buffer_load_dwordx4 v[224:227], v1, s[12:15], s30 offen offset:0 sc1
  buffer_load_dwordx4 v[228:231], v1, s[12:15], s30 offen offset:1024 sc1
  buffer_load_dwordx4 v[232:235], v1, s[12:15], s30 offen offset:2048 sc1
  buffer_load_dwordx4 v[236:239], v1, s[12:15], s30 offen offset:3072 sc1
  s_add_u32 s30, s30, 4096
  buffer_load_dwordx4 v[116:119], v1, s[12:15], s30 offen offset:0 sc1
  buffer_load_dwordx4 v[120:123], v1, s[12:15], s30 offen offset:1024 sc1
  buffer_load_dwordx4 v[124:127], v1, s[12:15], s30 offen offset:2048 sc1
  buffer_load_dwordx4 v[128:131], v1, s[12:15], s30 offen offset:3072 sc1
  s_add_u32 s30, s30, 4096
  buffer_load_dwordx4 v[152:155], v1, s[12:15], s30 offen offset:0 sc1
  buffer_load_dwordx4 v[156:159], v1, s[12:15], s30 offen offset:1024 sc1
  buffer_load_dwordx4 v[160:163], v1, s[12:15], s30 offen offset:2048 sc1
  buffer_load_dwordx4 v[164:167], v1, s[12:15], s30 offen offset:3072 sc1
  s_add_u32 s30, s30, 4096
  buffer_load_dwordx4 v[188:191], v1, s[12:15], s30 offen offset:0 sc1
  buffer_load_dwordx4 v[192:195], v1, s[12:15], s30 offen offset:1024 sc1
  buffer_load_dwordx4 v[196:199], v1, s[12:15], s30 offen offset:2048 sc1
  buffer_load_dwordx4 v[200:203], v1, s[12:15], s30 offen offset:3072 sc1
  s_add_u32 s30, s30, 4096
  s_waitcnt vmcnt(12)
  v_mfma_f32_16x16x32_bf16 v[16:19], v[204:207], v[224:227], v[16:19]
  v_mfma_f32_16x16x32_bf16 v[20:23], v[204:207], v[228:231], v[20:23]
  v_mfma_f32_16x16x32_bf16 v[24:27], v[204:207], v[232:235], v[24:27]
  v_mfma_f32_16x16x32_bf16 v[28:31], v[204:207], v[236:239], v[28:31]
  buffer_load_dwordx4 v[204:207], v1, s[12:15], s31 offen offset:0
  v_mfma_f32_16x16x32_bf16 v[32:35], v[208:211], v[224:227], v[32:35]
  v_mfma_f32_16x16x32_bf16 v[36:39], v[208:211], v[228:231], v[36:39]
  v_mfma_f32_16x16x32_bf16 v[40:43], v[208:211], v[232:235], v[40:43]
  v_mfma_f32_16x16x32_bf16 v[44:47], v[208:211], v[236:239], v[44:47]
  buffer_load_dwordx4 v[208:211], v1, s[12:15], s31 offen offset:1024
  v_mfma_f32_16x16x32_bf16 v[48:51], v[212:215], v[224:227], v[48:51]
  v_mfma_f32_16x16x32_bf16 v[52:55], v[212:215], v[228:231], v[52:55]
  v_mfma_f32_16x16x32_bf16 v[56:59], v[212:215], v[232:235], v[56:59]
  v_mfma_f32_16x16x32_bf16 v[60:63], v[212:215], v[236:239], v[60:63]
  buffer_load_dwordx4 v[212:215], v1, s[12:15], s31 offen offset:2048
  v_mfma_f32_16x16x32_bf16 v[64:67], v[216:219], v[224:227], v[64:67]
  v_mfma_f32_16x16x32_bf16 v[68:71], v[216:219], v[228:231], v[68:71]
  v_mfma_f32_16x16x32_bf16 v[72:75], v[216:219], v[232:235], v[72:75]
  v_mfma_f32_16x16x32_bf16 v[76:79], v[216:219], v[236:239], v[76:79]
  buffer_load_dwordx4 v[216:219], v1, s[12:15], s31 offen offset:3072
  v_mfma_f32_16x16x32_bf16 v[80:83], v[220:223], v[224:227], v[80:83]
  v_mfma_f32_16x16x32_bf16 v[84:87], v[220:223], v[228:231], v[84:87]
  buffer_load_dwordx4 v[224:227], v1, s[12:15], s30 offen offset:0 sc1
  v_mfma_f32_16x16x32_bf16 v[88:91], v[220:223], v[232:235], v[88:91]
  buffer_load_dwordx4 v[228:231], v1, s[12:15], s30 offen offset:1024 sc1
  v_mfma_f32_16x16x32_bf16 v[92:95], v[220:223], v[236:239], v[92:95]
  buffer_load_dwordx4 v[232:235], v1, s[12:15], s30 offen offset:2048 sc1
  buffer_load_dwordx4 v[220:223], v2, s[12:15], s31 offen
  s_add_u32 s31, s31, 40960
  buffer_load_dwordx4 v[236:239], v1, s[12:15], s30 offen offset:3072 sc1
  s_add_u32 s30, s30, 4096
  s_waitcnt vmcnt(17)
  v_mfma_f32_16x16x32_bf16 v[16:19], v[96:99], v[116:119], v[16:19]
  v_mfma_f32_16x16x32_bf16 v[20:23], v[96:99], v[120:123], v[20:23]
  v_mfma_f32_16x16x32_bf16 v[24:27], v[96:99], v[124:127], v[24:27]
  v_mfma_f32_16x16x32_bf16 v[28:31], v[96:99], v[128:131], v[28:31]
  v_mfma_f32_16x16x32_bf16 v[32:35], v[100:103], v[116:119], v[32:35]
  v_mfma_f32_16x16x32_bf16 v[36:39], v[100:103], v[120:123], v[36:39]
  v_mfma_f32_16x16x32_bf16 v[40:43], v[100:103], v[124:127], v[40:43]
  v_mfma_f32_16x16x32_bf16 v[44:47], v[100:103], v[128:131], v[44:47]
  v_mfma_f32_16x16x32_bf16 v[48:51], v[104:107], v[116:119], v[48:51]
  v_mfma_f32_16x16x32_bf16 v[52:55], v[104:107], v[120:123], v[52:55]
  v_mfma_f32_16x16x32_bf16 v[56:59], v[104:107], v[124:127], v[56:59]
  v_mfma_f32_16x16x32_bf16 v[60:63], v[104:107], v[128:131], v[60:63]
  v_mfma_f32_16x16x32_bf16 v[64:67], v[108:111], v[116:119], v[64:67]
  v_mfma_f32_16x16x32_bf16 v[68:71], v[108:111], v[120:123], v[68:71]
  v_mfma_f32_16x16x32_bf16 v[72:75], v[108:111], v[124:127], v[72:75]
  v_mfma_f32_16x16x32_bf16 v[76:79], v[108:111], v[128:131], v[76:79]
  v_mfma_f32_16x16x32_bf16 v[80:83], v[112:115], v[116:119], v[80:83]
  v_mfma_f32_16x16x32_bf16 v[84:87], v[112:115], v[120:123], v[84:87]
  v_mfma_f32_16x16x32_bf16 v[88:91], v[112:115], v[124:127], v[88:91]
  v_mfma_f32_16x16x32_bf16 v[92:95], v[112:115], v[128:131], v[92:95]
  s_waitcnt vmcnt(13)
  v_mfma_f32_16x16x32_bf16 v[16:19], v[132:135], v[152:155], v[16:19]
  v_mfma_f32_16x16x32_bf16 v[20:23], v[132:135], v[156:159], v[20:23]
  v_mfma_f32_16x16x32_bf16 v[24:27], v[132:135], v[160:163], v[24:27]
  v_mfma_f32_16x16x32_bf16 v[28:31], v[132:135], v[164:167], v[28:31]
  v_mfma_f32_16x16x32_bf16 v[32:35], v[136:139], v[152:155], v[32:35]
  v_mfma_f32_16x16x32_bf16 v[36:39], v[136:139], v[156:159], v[36:39]
  v_mfma_f32_16x16x32_bf16 v[40:43], v[136:139], v[160:163], v[40:43]
  v_mfma_f32_16x16x32_bf16 v[44:47], v[136:139], v[164:167], v[44:47]
  v_mfma_f32_16x16x32_bf16 v[48:51], v[140:143], v[152:155], v[48:51]
  v_mfma_f32_16x16x32_bf16 v[52:55], v[140:143], v[156:159], v[52:55]
  v_mfma_f32_16x16x32_bf16 v[56:59], v[140:143], v[160:163], v[56:59]
  v_mfma_f32_16x16x32_bf16 v[60:63], v[140:143], v[164:167], v[60:63]
  v_mfma_f32_16x16x32_bf16 v[64:67], v[144:147], v[152:155], v[64:67]
  v_mfma_f32_16x16x32_bf16 v[68:71], v[144:147], v[156:159], v[68:71]
  v_mfma_f32_16x16x32_bf16 v[72:75], v[144:147], v[160:163], v[72:75]
  v_mfma_f32_16x16x32_bf16 v[76:79], v[144:147], v[164:167], v[76:79]
  v_mfma_f32_16x16x32_bf16 v[80:83], v[148:151], v[152:155], v[80:83]
  v_mfma_f32_16x16x32_bf16 v[84:87], v[148:151], v[156:159], v[84:87]
  v_mfma_f32_16x16x32_bf16 v[88:91], v[148:151], v[160:163], v[88:91]
  v_mfma_f32_16x16x32_bf16 v[92:95], v[148:151], v[164:167], v[92:95]
  s_waitcnt vmcnt(9)
  v_mfma_f32_16x16x32_bf16 v[16:19], v[168:171], v[188:191], v[16:19]
  v_mfma_f32_16x16x32_bf16 v[20:23], v[168:171], v[192:195], v[20:23]
  v_mfma_f32_16x16x32_bf16 v[24:27], v[168:171], v[196:199], v[24:27]
  v_mfma_f32_16x16x32_bf16 v[28:31], v[168:171], v[200:203], v[28:31]
  v_mfma_f32_16x16x32_bf16 v[32:35], v[172:175], v[188:191], v[32:35]
  v_mfma_f32_16x16x32_bf16 v[36:39], v[172:175], v[192:195], v[36:39]
  v_mfma_f32_16x16x32_bf16 v[40:43], v[172:175], v[196:199], v[40:43]
  v_mfma_f32_16x16x32_bf16 v[44:47], v[172:175], v[200:203], v[44:47]
  v_mfma_f32_16x16x32_bf16 v[48:51], v[176:179], v[188:191], v[48:51]
  v_mfma_f32_16x16x32_bf16 v[52:55], v[176:179], v[192:195], v[52:55]
  v_mfma_f32_16x16x32_bf16 v[56:59], v[176:179], v[196:199], v[56:59]
  v_mfma_f32_16x16x32_bf16 v[60:63], v[176:179], v[200:203], v[60:63]
  v_mfma_f32_16x16x32_bf16 v[64:67], v[180:183], v[188:191], v[64:67]
  v_mfma_f32_16x16x32_bf16 v[68:71], v[180:183], v[192:195], v[68:71]
  v_mfma_f32_16x16x32_bf16 v[72:75], v[180:183], v[196:199], v[72:75]
  v_mfma_f32_16x16x32_bf16 v[76:79], v[180:183], v[200:203], v[76:79]
  v_mfma_f32_16x16x32_bf16 v[80:83], v[184:187], v[188:191], v[80:83]
  v_mfma_f32_16x16x32_bf16 v[84:87], v[184:187], v[192:195], v[84:87]
  v_mfma_f32_16x16x32_bf16 v[88:91], v[184:187], v[196:199], v[88:91]
  v_mfma_f32_16x16x32_bf16 v[92:95], v[184:187], v[200:203], v[92:95]
  v_and_b32 v4, 15, v3
  v_lshrrev_b32 v5, 4, v3
  v_mul_u32_u24 v4, 336, v4
  v_lshl_add_u32 v4, v5, 4, v4
  s_mul_i32 s27, s24, 21504
  v_add_u32 v4, s27, v4
  s_waitcnt vmcnt(0)
  v_mfma_f32_16x16x32_bf16 v[16:19], v[204:207], v[224:227], v[16:19]
  v_mfma_f32_16x16x32_bf16 v[20:23], v[204:207], v[228:231], v[20:23]
  v_mfma_f32_16x16x32_bf16 v[24:27], v[204:207], v[232:235], v[24:27]
  v_mfma_f32_16x16x32_bf16 v[28:31], v[204:207], v[236:239], v[28:31]
  v_mfma_f32_16x16x32_bf16 v[32:35], v[208:211], v[224:227], v[32:35]
  v_mfma_f32_16x16x32_bf16 v[36:39], v[208:211], v[228:231], v[36:39]
  v_mfma_f32_16x16x32_bf16 v[40:43], v[208:211], v[232:235], v[40:43]
  v_mfma_f32_16x16x32_bf16 v[44:47], v[208:211], v[236:239], v[44:47]
  v_mfma_f32_16x16x32_bf16 v[48:51], v[212:215], v[224:227], v[48:51]
  ds_write_b128 v4, v[16:19] offset:0
  v_mfma_f32_16x16x32_bf16 v[52:55], v[212:215], v[228:231], v[52:55]
  ds_write_b128 v4, v[20:23] offset:5376
  v_mfma_f32_16x16x32_bf16 v[56:59], v[212:215], v[232:235], v[56:59]
  ds_write_b128 v4, v[24:27] offset:10752
  v_mfma_f32_16x16x32_bf16 v[60:63], v[212:215], v[236:239], v[60:63]
  ds_write_b128 v4, v[28:31] offset:16128
  v_mfma_f32_16x16x32_bf16 v[64:67], v[216:219], v[224:227], v[64:67]
  ds_write_b128 v4, v[32:35] offset:64
  v_mfma_f32_16x16x32_bf16 v[68:71], v[216:219], v[228:231], v[68:71]
  ds_write_b128 v4, v[36:39] offset:5440
  v_mfma_f32_16x16x32_bf16 v[72:75], v[216:219], v[232:235], v[72:75]
  ds_write_b128 v4, v[40:43] offset:10816
  v_mfma_f32_16x16x32_bf16 v[76:79], v[216:219], v[236:239], v[76:79]
  ds_write_b128 v4, v[44:47] offset:16192
  v_mfma_f32_16x16x32_bf16 v[80:83], v[220:223], v[224:227], v[80:83]
  ds_write_b128 v4, v[48:51] offset:128
  v_mfma_f32_16x16x32_bf16 v[84:87], v[220:223], v[228:231], v[84:87]
  ds_write_b128 v4, v[52:55] offset:5504
  v_mfma_f32_16x16x32_bf16 v[88:91], v[220:223], v[232:235], v[88:91]
  ds_write_b128 v4, v[56:59] offset:10880
  v_mfma_f32_16x16x32_bf16 v[92:95], v[220:223], v[236:239], v[92:95]
  ds_write_b128 v4, v[60:63] offset:16256
  ds_write_b128 v4, v[64:67] offset:192
  ds_write_b128 v4, v[68:71] offset:5568
  ds_write_b128 v4, v[72:75] offset:10944
  ds_write_b128 v4, v[76:79] offset:16320
  ds_write_b128 v4, v[80:83] offset:256
  ds_write_b128 v4, v[84:87] offset:5632
  ds_write_b128 v4, v[88:91] offset:11008
  ds_write_b128 v4, v[92:95] offset:16384
  s_branch K2_FINAL
K2_SIDE:
  s_and_b32 s32, s24, 1
  s_lshr_b32 s33, s26, 1
  s_and_b32 s29, s26, 1
  s_lshl_b32 s27, s25, 1
  s_add_u32 s29, s29, s27
  s_lshr_b32 s51, s25, 1
  v_mov_b32 v64, 0
  v_mov_b32 v65, 0
  v_mov_b32 v66, 0
  v_mov_b32 v67, 0
  s_sub_u32 s36, s24, 4
  s_mul_i32 s36, s36, 9216
  s_add_u32 s36, s36, 65536
  v_add_u32 v4, s36, v1
  ds_write_b128 v4, v[64:67] offset:0
  ds_write_b128 v4, v[64:67] offset:1024
  ds_write_b128 v4, v[64:67] offset:2048
  ds_write_b128 v4, v[64:67] offset:3072
  ds_write_b128 v4, v[64:67] offset:4096
  ds_write_b128 v4, v[64:67] offset:5120
  ds_write_b128 v4, v[64:67] offset:6144
  ds_write_b128 v4, v[64:67] offset:7168
  ds_write_b128 v4, v[64:67] offset:8192
  v_and_b32 v8, 255, v0
  v_add_u32 v9, 0, v8
  v_mul_u32_u24 v10, 9987, v9
  v_lshrrev_b32 v10, 20, v10
  v_mul_u32_u24 v11, 105, v10
  v_sub_u32 v11, v9, v11
  v_mul_u32_u24 v12, 52429, v11
  v_lshrrev_b32 v12, 18, v12
  v_mul_u32_u24 v13, 5, v12
  v_sub_u32 v13, v11, v13
  v_mul_u32_u24 v10, 20, v10
  v_add_u32 v12, v10, v12
  v_lshl_add_u32 v13, v13, 2, v10
  v_lshrrev_b32 v14, 4, v12
  v_and_b32 v12, 15, v12
  v_max_u32 v15, 1, v14
  v_subrev_u32 v15, 1, v15
  v_lshrrev_b32 v15, 1, v15
  v_lshlrev_b32 v15, 5, v15
  v_sub_u32 v13, v13, v15
  v_mul_u32_u24 v14, 2304, v14
  v_mul_u32_u24 v12, 144, v12
  v_add_u32 v14, v14, v12
  v_lshl_add_u32 v14, v13, 1, v14
  v_add_u32 v14, 65536, v14
  v_cmp_gt_u32 vcc, 100, v11
  v_mov_b32 v15, 98560
  s_nop 0
  v_cndmask_b32 v56, v15, v14, vcc
  v_add_u32 v9, 256, v8
  v_mul_u32_u24 v10, 9987, v9
  v_lshrrev_b32 v10, 20, v10
  v_mul_u32_u24 v11, 105, v10
  v_sub_u32 v11, v9, v11
  v_mul_u32_u24 v12, 52429, v11
  v_lshrrev_b32 v12, 18, v12
  v_mul_u32_u24 v13, 5, v12
  v_sub_u32 v13, v11, v13
  v_mul_u32_u24 v10, 20, v10
  v_add_u32 v12, v10, v12
  v_lshl_add_u32 v13, v13, 2, v10
  v_lshrrev_b32 v14, 4, v12
  v_and_b32 v12, 15, v12
  v_max_u32 v15, 1, v14
  v_subrev_u32 v15, 1, v15
  v_lshrrev_b32 v15, 1, v15
  v_lshlrev_b32 v15, 5, v15
  v_sub_u32 v13, v13, v15
  v_mul_u32_u24 v14, 2304, v14
  v_mul_u32_u24 v12, 144, v12
  v_add_u32 v14, v14, v12
  v_lshl_add_u32 v14, v13, 1, v14
  v_add_u32 v14, 65536, v14
  v_cmp_gt_u32 vcc, 100, v11
  v_mov_b32 v15, 98560
  s_nop 0
  v_cndmask_b32 v57, v15, v14, vcc
  v_add_u32 v9, 512, v8
  v_mul_u32_u24 v10, 9987, v9
  v_lshrrev_b32 v10, 20, v10
  v_mul_u32_u24 v11, 105, v10
  v_sub_u32 v11, v9, v11
  v_mul_u32_u24 v12, 52429, v11
  v_lshrrev_b32 v12, 18, v12
  v_mul_u32_u24 v13, 5, v12
  v_sub_u32 v13, v11, v13
  v_mul_u32_u24 v10, 20, v10
  v_add_u32 v12, v10, v12
  v_lshl_add_u32 v13, v13, 2, v10
  v_lshrrev_b32 v14, 4, v12
  v_and_b32 v12, 15, v12
  v_max_u32 v15, 1, v14
  v_subrev_u32 v15, 1, v15
  v_lshrrev_b32 v15, 1, v15
  v_lshlrev_b32 v15, 5, v15
  v_sub_u32 v13, v13, v15
  v_mul_u32_u24 v14, 2304, v14
  v_mul_u32_u24 v12, 144, v12
  v_add_u32 v14, v14, v12
  v_lshl_add_u32 v14, v13, 1, v14
  v_add_u32 v14, 65536, v14
  v_cmp_gt_u32 vcc, 100, v11
  v_mov_b32 v15, 98560
  s_nop 0
  v_cndmask_b32 v58, v15, v14, vcc
  v_add_u32 v9, 768, v8
  v_mul_u32_u24 v10, 9987, v9
  v_lshrrev_b32 v10, 20, v10
  v_mul_u32_u24 v11, 105, v10
  v_sub_u32 v11, v9, v11
  v_mul_u32_u24 v12, 52429, v11
  v_lshrrev_b32 v12, 18, v12
  v_mul_u32_u24 v13, 5, v12
  v_sub_u32 v13, v11, v13
  v_mul_u32_u24 v10, 20, v10
  v_add_u32 v12, v10, v12
  v_lshl_add_u32 v13, v13, 2, v10
  v_lshrrev_b32 v14, 4, v12
  v_and_b32 v12, 15, v12
  v_max_u32 v15, 1, v14
  v_subrev_u32 v15, 1, v15
  v_lshrrev_b32 v15, 1, v15
  v_lshlrev_b32 v15, 5, v15
  v_sub_u32 v13, v13, v15
  v_mul_u32_u24 v14, 2304, v14
  v_mul_u32_u24 v12, 144, v12
  v_add_u32 v14, v14, v12
  v_lshl_add_u32 v14, v13, 1, v14
  v_add_u32 v14, 65536, v14
  v_cmp_gt_u32 vcc, 100, v11
  v_mov_b32 v15, 98560
  s_nop 0
  v_cndmask_b32 v59, v15, v14, vcc
  v_cmp_gt_u32 vcc, 840, v9
  s_nop 1
  v_cndmask_b32 v59, v15, v59, vcc
  v_mul_u32_u24 v10, 41944, v8
  v_lshrrev_b32 v10, 20, v10
  v_mul_u32_u24 v11, 25, v10
  v_sub_u32 v11, v8, v11
  v_mul_u32_u24 v12, 52429, v11
  v_lshrrev_b32 v12, 18, v12
  v_mul_u32_u24 v13, 5, v12
  v_sub_u32 v13, v11, v13
  v_mul_u32_u24 v14, 1680, v10
  v_lshl_add_u32 v14, v13, 4, v14
  v_add_u32 v61, 1600, v14
  v_mul_u32_u24 v10, 20, v10
  v_lshl_add_u32 v12, v12, 2, v10
  v_lshl_add_u32 v13, v13, 2, v10
  v_lshrrev_b32 v14, 4, v12
  v_bfe_u32 v12, v12, 2, 2
  v_cmp_le_u32 vcc, 4, v14
  s_nop 1
  v_cndmask_b32 v9, 0, 1, vcc
  v_cmp_le_u32 vcc, 6, v14
  s_nop 1
  v_cndmask_b32 v10, 0, 1, vcc
  v_add_u32 v9, v9, v10
  v_lshlrev_b32 v11, 2, v9
  v_sub_u32 v11, v11, v10
  v_sub_u32 v11, v11, v10
  v_sub_u32 v14, v14, v11
  v_lshl_add_u32 v14, v12, 2, v14
  v_mul_u32_u24 v14, 208, v14
  v_lshlrev_b32 v11, 5, v9
  v_sub_u32 v13, v13, v11
  v_lshl_add_u32 v14, v13, 1, v14
  v_mul_u32_u24 v9, 3328, v9
  v_add_u32 v14, v14, v9
  v_add_u32 v14, 88576, v14
  v_cmp_gt_u32 vcc, 200, v8
  v_mov_b32 v15, 98560
  s_nop 0
  v_cndmask_b32 v60, v15, v14, vcc
  v_min_u32 v61, 13424, v61
  v_lshlrev_b32 v62, 4, v8
  s_waitcnt lgkmcnt(0)
  v_mov_b32 v4, 112640
  v_mov_b32 v5, 1
  ds_add_u32 v4, v5 offset:0
  s_mov_b32 s39, 8388608
K2_ZW:
  ds_read_b32 v5, v4 offset:0
  s_waitcnt lgkmcnt(0)
  v_readfirstlane_b32 s40, v5
  s_sub_u32 s39, s39, 1
  s_cmp_eq_u32 s39, 0
  s_cbranch_scc1 K2_ZW_X
  s_nop 0
  s_cmp_ge_u32 s40, 256
  s_cbranch_scc0 K2_ZW
K2_ZW_X:
  s_cmp_eq_u32 s24, 4
  s_cbranch_scc0 K2_SRDY
  s_lshl_b32 s40, s33, 10
  s_and_b32 s41, s2, 3
  s_lshl_b32 s41, s41, 7
  s_add_u32 s40, s40, s41
  s_add_u32 s40, s40, 16848896
  v_and_b32 v8, 1, v3
  v_lshlrev_b32 v8, 9, v8
  v_add_u32 v8, s40, v8
  s_lshl_b32 s40, s51, 7
  s_add_u32 s40, s40, 16852992
  v_mov_b32 v9, s40
  v_and_b32 v10, 2, v3
  v_cmp_eq_u32 vcc, 0, v10
  s_nop 1
  v_cndmask_b32 v6, v9, v8, vcc
  v_mov_b32 v9, 8
  v_mov_b32 v10, 16
  v_cndmask_b32 v8, v9, v10, vcc
  s_mov_b32 s39, 2097152
K2_PK:
  buffer_load_dword v7, v6, s[12:15], 0 offen sc1
  s_waitcnt vmcnt(0)
  v_cmp_eq_u32 vcc, v8, v7
  s_sub_u32 s39, s39, 1
  s_cmp_eq_u32 s39, 0
  s_cbranch_scc1 K2_PK_X
  s_nop 0
  s_cmp_eq_u64 vcc, -1
  s_cbranch_scc1 K2_PK_X
  s_sleep 2
  s_branch K2_PK
K2_PK_X:
  v_mov_b32 v4, 112640
  v_mov_b32 v5, 1
  ds_write_b32 v4, v5 offset:12
K2_SRDY:
  v_mov_b32 v4, 112640
  s_mov_b32 s39, 8388608
K2_KWAIT:
  ds_read_b32 v5, v4 offset:12
  s_waitcnt lgkmcnt(0)
  v_readfirstlane_b32 s40, v5
  s_sub_u32 s39, s39, 1
  s_cmp_eq_u32 s39, 0
  s_cbranch_scc1 K2_KWAIT_X
  s_nop 0
  s_cmp_eq_u32 s40, 0
  s_cbranch_scc0 K2_KWAIT_X
  s_sleep 1
  s_branch K2_KWAIT
K2_KWAIT_X:
  s_setprio 3
  s_mul_i32 s36, s33, 13440
  s_add_u32 s36, s36, 16777216
  buffer_load_dwordx4 v[64:67], v62, s[12:15], s36 offen sc1
  s_add_u32 s37, s36, 4096
  buffer_load_dwordx4 v[68:71], v62, s[12:15], s37 offen sc1
  s_add_u32 s37, s36, 8192
  buffer_load_dwordx4 v[72:75], v62, s[12:15], s37 offen sc1
  s_add_u32 s37, s36, 12288
  buffer_load_dwordx4 v[76:79], v62, s[12:15], s37 offen sc1
  buffer_load_dwordx4 v[80:83], v61, s[12:15], s36 offen sc1
  s_cmp_ge_u32 s24, 6
  s_cbranch_scc1 K2_O1
K2_O0:
  s_mul_i32 s36, s29, 20
  s_mul_i32 s37, s33, 5
  s_add_u32 s36, s36, s37
  s_add_u32 s36, s36, 0
  s_lshl_b32 s36, s36, 1
  s_add_u32 s36, s36, s32
  s_lshl_b32 s36, s36, 10
  s_add_u32 s36, s36, 10485760
  buffer_load_dwordx4 v[8:11], v1, s[12:15], s36 offen offset:0 sc1
  buffer_load_dwordx4 v[12:15], v1, s[12:15], s36 offen offset:2048 sc1
  buffer_load_dwordx4 v[16:19], v2, s[12:15], s36 offen offset:0 sc1
  buffer_load_dwordx4 v[20:23], v2, s[12:15], s36 offen offset:2048 sc1
  s_setprio 0
  s_waitcnt vmcnt(4)
  v_cvt_pk_bf16_f32 v64, v64, v65
  v_cvt_pk_bf16_f32 v65, v66, v67
  ds_write_b64 v56, v[64:65]
  v_cvt_pk_bf16_f32 v68, v68, v69
  v_cvt_pk_bf16_f32 v69, v70, v71
  ds_write_b64 v57, v[68:69]
  v_cvt_pk_bf16_f32 v72, v72, v73
  v_cvt_pk_bf16_f32 v73, v74, v75
  ds_write_b64 v58, v[72:73]
  v_cvt_pk_bf16_f32 v76, v76, v77
  v_cvt_pk_bf16_f32 v77, v78, v79
  ds_write_b64 v59, v[76:77]
  v_cvt_pk_bf16_f32 v80, v80, v81
  v_cvt_pk_bf16_f32 v81, v82, v83
  ds_write_b64 v60, v[80:81]
  s_waitcnt lgkmcnt(0)
  v_mov_b32 v4, 112640
  v_mov_b32 v5, 1
  ds_add_u32 v4, v5 offset:28
  s_mov_b32 s39, 8388608
K2_O0_W:
  ds_read_b32 v5, v4 offset:28
  s_waitcnt lgkmcnt(0)
  v_readfirstlane_b32 s40, v5
  s_sub_u32 s39, s39, 1
  s_cmp_eq_u32 s39, 0
  s_cbranch_scc1 K2_O0_W_X
  s_nop 0
  s_cmp_ge_u32 s40, 256
  s_cbranch_scc0 K2_O0_W
K2_O0_W_X:
  v_and_b32 v4, 15, v3
  v_lshrrev_b32 v5, 4, v3
  v_mul_u32_u24 v6, 144, v4
  v_lshl_add_u32 v6, v5, 3, v6
  v_mul_u32_u24 v7, 208, v4
  v_lshl_add_u32 v7, v5, 3, v7
  v_add_u32 v64, 65536, v6
  v_add_u32 v65, 67840, v6
  v_add_u32 v66, 70144, v6
  v_add_u32 v67, 72448, v6
  v_add_u32 v68, 74752, v6
  v_add_u32 v69, 77056, v6
  v_add_u32 v72, 88576, v7
  v_add_u32 v73, 91904, v7
  ds_read2_b64 v[96:99], v64 offset0:0 offset1:4
  ds_read2_b64 v[100:103], v65 offset0:0 offset1:4
  ds_read2_b64 v[104:107], v65 offset0:8 offset1:12
  ds_read2_b64 v[108:111], v66 offset0:0 offset1:4
  ds_read2_b64 v[112:115], v66 offset0:8 offset1:12
  ds_read2_b64 v[116:119], v67 offset0:0 offset1:4
  ds_read2_b64 v[120:123], v67 offset0:8 offset1:12
  ds_read2_b64 v[124:127], v68 offset0:0 offset1:4
  ds_read2_b64 v[128:131], v68 offset0:8 offset1:12
  ds_read2_b64 v[132:135], v69 offset0:0 offset1:4
  ds_read2_b64 v[136:139], v69 offset0:8 offset1:12
  ds_read2_b64 v[140:143], v72 offset0:0 offset1:4
  s_waitcnt lgkmcnt(4)
  ds_read2_b64 v[144:147], v72 offset0:8 offset1:12
  ds_read2_b64 v[148:151], v72 offset0:16 offset1:20
  ds_read2_b64 v[152:155], v73 offset0:0 offset1:4
  ds_read2_b64 v[156:159], v73 offset0:8 offset1:12
  ds_read2_b64 v[160:163], v73 offset0:16 offset1:20
  s_waitcnt vmcnt(0) lgkmcnt(0)
  v_mfma_f32_16x16x32_bf16 v[24:27], v[96:99], v[8:11], 0
  v_mfma_f32_16x16x32_bf16 v[28:31], v[100:103], v[8:11], 0
  v_mfma_f32_16x16x32_bf16 v[28:31], v[104:107], v[12:15], v[28:31]
  v_mfma_f32_16x16x32_bf16 v[32:35], v[108:111], v[8:11], 0
  v_mfma_f32_16x16x32_bf16 v[32:35], v[112:115], v[12:15], v[32:35]
  v_mfma_f32_16x16x32_bf16 v[36:39], v[116:119], v[12:15], 0
  v_mfma_f32_16x16x32_bf16 v[36:39], v[120:123], v[16:19], v[36:39]
  v_mfma_f32_16x16x32_bf16 v[40:43], v[124:127], v[12:15], 0
  v_mfma_f32_16x16x32_bf16 v[40:43], v[128:131], v[16:19], v[40:43]
  v_mfma_f32_16x16x32_bf16 v[44:47], v[132:135], v[16:19], 0
  v_mfma_f32_16x16x32_bf16 v[44:47], v[136:139], v[20:23], v[44:47]
  v_mfma_f32_16x16x32_bf16 v[48:51], v[140:143], v[8:11], 0
  v_mfma_f32_16x16x32_bf16 v[48:51], v[144:147], v[12:15], v[48:51]
  v_mfma_f32_16x16x32_bf16 v[48:51], v[148:151], v[16:19], v[48:51]
  v_mfma_f32_16x16x32_bf16 v[52:55], v[152:155], v[12:15], 0
  v_mfma_f32_16x16x32_bf16 v[52:55], v[156:159], v[16:19], v[52:55]
  v_mfma_f32_16x16x32_bf16 v[52:55], v[160:163], v[20:23], v[52:55]
  s_mov_b32 s40, 0x358637bd
  s_nop 3
  v_add_f32 v64, s40, v48
  v_add_f32 v65, s40, v49
  v_add_f32 v66, s40, v50
  v_add_f32 v67, s40, v51
  v_add_f32 v68, s40, v52
  v_add_f32 v69, s40, v53
  v_rcp_f32 v64, v64
  v_rcp_f32 v65, v65
  v_rcp_f32 v66, v66
  v_rcp_f32 v67, v67
  v_rcp_f32 v68, v68
  v_rcp_f32 v69, v69
  v_mul_f32 v24, v24, v64
  v_mul_f32 v25, v25, v64
  v_mul_f32 v26, v26, v64
  v_mul_f32 v27, v27, v64
  v_mul_f32 v28, v28, v65
  v_mul_f32 v29, v29, v65
  v_mul_f32 v30, v30, v65
  v_mul_f32 v31, v31, v65
  v_mul_f32 v32, v32, v66
  v_mul_f32 v33, v33, v66
  v_mul_f32 v34, v34, v66
  v_mul_f32 v35, v35, v66
  v_mul_f32 v36, v36, v67
  v_mul_f32 v37, v37, v67
  v_mul_f32 v38, v38, v67
  v_mul_f32 v39, v39, v67
  v_mul_f32 v40, v40, v68
  v_mul_f32 v41, v41, v68
  v_mul_f32 v42, v42, v68
  v_mul_f32 v43, v43, v68
  v_mul_f32 v44, v44, v69
  v_mul_f32 v45, v45, v69
  v_mul_f32 v46, v46, v69
  v_mul_f32 v47, v47, v69
  v_cvt_pk_bf16_f32 v96, v24, v25
  v_cvt_pk_bf16_f32 v97, v26, v27
  v_cvt_pk_bf16_f32 v98, v28, v29
  v_cvt_pk_bf16_f32 v99, v30, v31
  v_cvt_pk_bf16_f32 v100, v32, v33
  v_cvt_pk_bf16_f32 v101, v34, v35
  v_cvt_pk_bf16_f32 v102, v36, v37
  v_cvt_pk_bf16_f32 v103, v38, v39
  v_cvt_pk_bf16_f32 v104, v40, v41
  v_cvt_pk_bf16_f32 v105, v42, v43
  v_cvt_pk_bf16_f32 v106, v44, v45
  v_cvt_pk_bf16_f32 v107, v46, v47
  s_mul_i32 s36, s33, 5
  s_mul_i32 s37, s33, 14
  s_cmp_ge_u32 s33, 2
  s_cselect_b32 s40, 1, 0
  s_sub_u32 s37, s37, s40
  s_cmp_ge_u32 s33, 3
  s_cselect_b32 s40, 1, 0
  s_sub_u32 s37, s37, s40
  s_add_u32 s37, s37, 14
  s_add_u32 s36, s36, s37
  s_add_u32 s36, s36, 0
  s_mul_i32 s37, s25, 74
  s_add_u32 s36, s36, s37
  s_lshl_b32 s36, s36, 2
  s_and_b32 s37, s26, 1
  s_lshl_b32 s37, s37, 1
  s_add_u32 s37, s37, s32
  s_add_u32 s36, s36, s37
  s_lshl_b32 s36, s36, 10
  s_setprio 3
  buffer_store_dwordx4 v[96:99], v1, s[12:15], s36 offen sc1
  s_add_u32 s36, s36, 4096
  buffer_store_dwordx4 v[100:103], v1, s[12:15], s36 offen sc1
  s_add_u32 s36, s36, 4096
  buffer_store_dwordx4 v[104:107], v1, s[12:15], s36 offen sc1
  s_waitcnt vmcnt(0)
  s_lshl_b32 s36, s25, 7
  s_add_u32 s36, s36, 16834560
  s_lshl_b32 s37, s26, 2
  s_add_u32 s37, s37, s24
  s_sub_u32 s37, s37, 4
  s_lshl_b32 s37, s37, 2
  s_add_u32 s37, s37, s36
  v_mov_b32 v6, 1
  v_mov_b32 v7, 0
  buffer_store_dword v6, v7, s[12:15], s37 offen sc1
  s_cmp_eq_u32 s24, 4
  s_cbranch_scc0 K2_FINAL
  v_and_b32 v6, 31, v3
  v_lshlrev_b32 v6, 2, v6
  s_setprio 0
  v_mov_b32 v4, 112640
  s_mov_b32 s39, 8388608
K2_TWAIT:
  ds_read_b32 v5, v4 offset:32
  s_waitcnt lgkmcnt(0)
  v_readfirstlane_b32 s40, v5
  s_sub_u32 s39, s39, 1
  s_cmp_eq_u32 s39, 0
  s_cbranch_scc1 K2_TWAIT_X
  s_nop 0
  s_cmp_eq_u32 s40, 0
  s_cbranch_scc0 K2_TWAIT_X
  s_sleep 1
  s_branch K2_TWAIT
K2_TWAIT_X:
  s_mov_b32 s39, 2097152
K2_POLL:
  buffer_load_dword v7, v6, s[12:15], s36 offen sc1
  s_waitcnt vmcnt(0)
  v_cmp_eq_u32 vcc, 1, v7
  s_sub_u32 s39, s39, 1
  s_cmp_eq_u32 s39, 0
  s_cbranch_scc1 K2_POLL_D
  s_nop 0
  s_cmp_eq_u64 vcc, -1
  s_cbranch_scc1 K2_POLL_D
  s_sleep 3
  s_branch K2_POLL
K2_POLL_D:
  v_mov_b32 v4, 112640
  v_mov_b32 v5, 1
  ds_write_b32 v4, v5 offset:4
  s_branch K2_FINAL
K2_O1:
  s_mul_i32 s36, s29, 20
  s_mul_i32 s37, s33, 5
  s_add_u32 s36, s36, s37
  s_add_u32 s36, s36, 2
  s_lshl_b32 s36, s36, 1
  s_add_u32 s36, s36, s32
  s_lshl_b32 s36, s36, 10
  s_add_u32 s36, s36, 10485760
  buffer_load_dwordx4 v[8:11], v1, s[12:15], s36 offen offset:0 sc1
  buffer_load_dwordx4 v[12:15], v1, s[12:15], s36 offen offset:2048 sc1
  buffer_load_dwordx4 v[16:19], v2, s[12:15], s36 offen offset:0 sc1
  s_setprio 0
  s_waitcnt vmcnt(3)
  v_cvt_pk_bf16_f32 v64, v64, v65
  v_cvt_pk_bf16_f32 v65, v66, v67
  ds_write_b64 v56, v[64:65]
  v_cvt_pk_bf16_f32 v68, v68, v69
  v_cvt_pk_bf16_f32 v69, v70, v71
  ds_write_b64 v57, v[68:69]
  v_cvt_pk_bf16_f32 v72, v72, v73
  v_cvt_pk_bf16_f32 v73, v74, v75
  ds_write_b64 v58, v[72:73]
  v_cvt_pk_bf16_f32 v76, v76, v77
  v_cvt_pk_bf16_f32 v77, v78, v79
  ds_write_b64 v59, v[76:77]
  v_cvt_pk_bf16_f32 v80, v80, v81
  v_cvt_pk_bf16_f32 v81, v82, v83
  ds_write_b64 v60, v[80:81]
  s_waitcnt lgkmcnt(0)
  v_mov_b32 v4, 112640
  v_mov_b32 v5, 1
  ds_add_u32 v4, v5 offset:28
  s_mov_b32 s39, 8388608
K2_O1_W:
  ds_read_b32 v5, v4 offset:28
  s_waitcnt lgkmcnt(0)
  v_readfirstlane_b32 s40, v5
  s_sub_u32 s39, s39, 1
  s_cmp_eq_u32 s39, 0
  s_cbranch_scc1 K2_O1_W_X
  s_nop 0
  s_cmp_ge_u32 s40, 256
  s_cbranch_scc0 K2_O1_W
K2_O1_W_X:
  v_and_b32 v4, 15, v3
  v_lshrrev_b32 v5, 4, v3
  v_mul_u32_u24 v6, 144, v4
  v_lshl_add_u32 v6, v5, 3, v6
  v_mul_u32_u24 v7, 208, v4
  v_lshl_add_u32 v7, v5, 3, v7
  v_add_u32 v64, 79360, v6
  v_add_u32 v65, 81664, v6
  v_add_u32 v66, 83968, v6
  v_add_u32 v67, 86272, v6
  v_add_u32 v72, 95232, v7
  ds_read2_b64 v[96:99], v64 offset0:0 offset1:4
  ds_read2_b64 v[100:103], v64 offset0:8 offset1:12
  ds_read2_b64 v[104:107], v65 offset0:0 offset1:4
  ds_read2_b64 v[108:111], v65 offset0:8 offset1:12
  ds_read2_b64 v[112:115], v66 offset0:0 offset1:4
  ds_read2_b64 v[116:119], v66 offset0:8 offset1:12
  ds_read2_b64 v[120:123], v67 offset0:0 offset1:4
  ds_read2_b64 v[124:127], v72 offset0:0 offset1:4
  ds_read2_b64 v[128:131], v72 offset0:8 offset1:12
  ds_read2_b64 v[132:135], v72 offset0:16 offset1:20
  s_waitcnt vmcnt(0) lgkmcnt(0)
  v_mfma_f32_16x16x32_bf16 v[24:27], v[96:99], v[8:11], 0
  v_mfma_f32_16x16x32_bf16 v[24:27], v[100:103], v[12:15], v[24:27]
  v_mfma_f32_16x16x32_bf16 v[28:31], v[104:107], v[12:15], 0
  v_mfma_f32_16x16x32_bf16 v[28:31], v[108:111], v[16:19], v[28:31]
  v_mfma_f32_16x16x32_bf16 v[32:35], v[112:115], v[12:15], 0
  v_mfma_f32_16x16x32_bf16 v[32:35], v[116:119], v[16:19], v[32:35]
  v_mfma_f32_16x16x32_bf16 v[36:39], v[120:123], v[16:19], 0
  v_mfma_f32_16x16x32_bf16 v[48:51], v[124:127], v[8:11], 0
  v_mfma_f32_16x16x32_bf16 v[48:51], v[128:131], v[12:15], v[48:51]
  v_mfma_f32_16x16x32_bf16 v[48:51], v[132:135], v[16:19], v[48:51]
  s_mov_b32 s40, 0x358637bd
  s_nop 6
  v_add_f32 v64, s40, v48
  v_add_f32 v65, s40, v49
  v_add_f32 v66, s40, v50
  v_add_f32 v67, s40, v51
  v_rcp_f32 v64, v64
  v_rcp_f32 v65, v65
  v_rcp_f32 v66, v66
  v_rcp_f32 v67, v67
  v_mul_f32 v24, v24, v64
  v_mul_f32 v25, v25, v64
  v_mul_f32 v26, v26, v64
  v_mul_f32 v27, v27, v64
  v_mul_f32 v28, v28, v65
  v_mul_f32 v29, v29, v65
  v_mul_f32 v30, v30, v65
  v_mul_f32 v31, v31, v65
  v_mul_f32 v32, v32, v66
  v_mul_f32 v33, v33, v66
  v_mul_f32 v34, v34, v66
  v_mul_f32 v35, v35, v66
  v_mul_f32 v36, v36, v67
  v_mul_f32 v37, v37, v67
  v_mul_f32 v38, v38, v67
  v_mul_f32 v39, v39, v67
  v_cvt_pk_bf16_f32 v96, v24, v25
  v_cvt_pk_bf16_f32 v97, v26, v27
  v_cvt_pk_bf16_f32 v98, v28, v29
  v_cvt_pk_bf16_f32 v99, v30, v31
  v_cvt_pk_bf16_f32 v100, v32, v33
  v_cvt_pk_bf16_f32 v101, v34, v35
  v_cvt_pk_bf16_f32 v102, v36, v37
  v_cvt_pk_bf16_f32 v103, v38, v39
  s_mul_i32 s36, s33, 5
  s_mul_i32 s37, s33, 14
  s_cmp_ge_u32 s33, 2
  s_cselect_b32 s40, 1, 0
  s_sub_u32 s37, s37, s40
  s_cmp_ge_u32 s33, 3
  s_cselect_b32 s40, 1, 0
  s_sub_u32 s37, s37, s40
  s_add_u32 s37, s37, 14
  s_add_u32 s36, s36, s37
  s_add_u32 s36, s36, 3
  s_mul_i32 s37, s25, 74
  s_add_u32 s36, s36, s37
  s_lshl_b32 s36, s36, 2
  s_and_b32 s37, s26, 1
  s_lshl_b32 s37, s37, 1
  s_add_u32 s37, s37, s32
  s_add_u32 s36, s36, s37
  s_lshl_b32 s36, s36, 10
  s_setprio 3
  buffer_store_dwordx4 v[96:99], v1, s[12:15], s36 offen sc1
  s_add_u32 s36, s36, 4096
  buffer_store_dwordx4 v[100:103], v1, s[12:15], s36 offen sc1
  s_waitcnt vmcnt(0)
  s_lshl_b32 s36, s25, 7
  s_add_u32 s36, s36, 16834560
  s_lshl_b32 s37, s26, 2
  s_add_u32 s37, s37, s24
  s_sub_u32 s37, s37, 4
  s_lshl_b32 s37, s37, 2
  s_add_u32 s37, s37, s36
  v_mov_b32 v6, 1
  v_mov_b32 v7, 0
  buffer_store_dword v6, v7, s[12:15], s37 offen sc1
  s_branch K2_FINAL
K2_FINAL:
  s_setprio 0
  s_waitcnt lgkmcnt(0)
  s_barrier
  ds_read_b128 v[16:19], v250 offset:0
  ds_read_b128 v[20:23], v250 offset:16
  ds_read_b128 v[24:27], v250 offset:21504
  ds_read_b128 v[28:31], v250 offset:21520
  ds_read_b128 v[32:35], v250 offset:43008
  ds_read_b128 v[36:39], v250 offset:43024
  ds_read_b128 v[40:43], v250 offset:64512
  ds_read_b128 v[44:47], v250 offset:64528
  s_cmp_ge_u32 s24, 2
  s_cbranch_scc1 K2_ONE
  ds_read_b128 v[48:51], v251 offset:0
  ds_read_b128 v[52:55], v251 offset:16
  ds_read_b128 v[56:59], v251 offset:21504
  ds_read_b128 v[60:63], v251 offset:21520
  ds_read_b128 v[64:67], v251 offset:43008
  ds_read_b128 v[68:71], v251 offset:43024
  ds_read_b128 v[72:75], v251 offset:64512
  ds_read_b128 v[76:79], v251 offset:64528
  s_waitcnt vmcnt(0) lgkmcnt(8)
  v_lshlrev_b32 v80, 16, v240
  v_and_b32 v81, 0xffff0000, v240
  v_lshlrev_b32 v82, 16, v241
  v_and_b32 v83, 0xffff0000, v241
  v_lshlrev_b32 v84, 16, v242
  v_and_b32 v85, 0xffff0000, v242
  v_lshlrev_b32 v86, 16, v243
  v_and_b32 v87, 0xffff0000, v243
  v_add_f32 v16, v16, v24
  v_add_f32 v32, v32, v40
  v_add_f32 v17, v17, v25
  v_add_f32 v33, v33, v41
  v_add_f32 v18, v18, v26
  v_add_f32 v34, v34, v42
  v_add_f32 v19, v19, v27
  v_add_f32 v35, v35, v43
  v_add_f32 v20, v20, v28
  v_add_f32 v36, v36, v44
  v_add_f32 v21, v21, v29
  v_add_f32 v37, v37, v45
  v_add_f32 v22, v22, v30
  v_add_f32 v38, v38, v46
  v_add_f32 v23, v23, v31
  v_add_f32 v39, v39, v47
  v_add_f32 v16, v16, v80
  v_add_f32 v17, v17, v81
  v_add_f32 v18, v18, v82
  v_add_f32 v19, v19, v83
  v_add_f32 v20, v20, v84
  v_add_f32 v21, v21, v85
  v_add_f32 v22, v22, v86
  v_add_f32 v23, v23, v87
  v_add_f32 v16, v16, v32
  v_add_f32 v17, v17, v33
  v_add_f32 v18, v18, v34
  v_add_f32 v19, v19, v35
  v_add_f32 v20, v20, v36
  v_add_f32 v21, v21, v37
  v_add_f32 v22, v22, v38
  v_add_f32 v23, v23, v39
  v_cvt_pk_bf16_f32 v88, v16, v17
  v_cvt_pk_bf16_f32 v89, v18, v19
  v_cvt_pk_bf16_f32 v90, v20, v21
  v_cvt_pk_bf16_f32 v91, v22, v23
  buffer_store_dwordx4 v[88:91], v248, s[20:23], 0 offen
  s_waitcnt lgkmcnt(0)
  v_lshlrev_b32 v96, 16, v244
  v_and_b32 v97, 0xffff0000, v244
  v_lshlrev_b32 v98, 16, v245
  v_and_b32 v99, 0xffff0000, v245
  v_lshlrev_b32 v100, 16, v246
  v_and_b32 v101, 0xffff0000, v246
  v_lshlrev_b32 v102, 16, v247
  v_and_b32 v103, 0xffff0000, v247
  v_add_f32 v48, v48, v56
  v_add_f32 v64, v64, v72
  v_add_f32 v49, v49, v57
  v_add_f32 v65, v65, v73
  v_add_f32 v50, v50, v58
  v_add_f32 v66, v66, v74
  v_add_f32 v51, v51, v59
  v_add_f32 v67, v67, v75
  v_add_f32 v52, v52, v60
  v_add_f32 v68, v68, v76
  v_add_f32 v53, v53, v61
  v_add_f32 v69, v69, v77
  v_add_f32 v54, v54, v62
  v_add_f32 v70, v70, v78
  v_add_f32 v55, v55, v63
  v_add_f32 v71, v71, v79
  v_add_f32 v48, v48, v96
  v_add_f32 v49, v49, v97
  v_add_f32 v50, v50, v98
  v_add_f32 v51, v51, v99
  v_add_f32 v52, v52, v100
  v_add_f32 v53, v53, v101
  v_add_f32 v54, v54, v102
  v_add_f32 v55, v55, v103
  v_add_f32 v48, v48, v64
  v_add_f32 v49, v49, v65
  v_add_f32 v50, v50, v66
  v_add_f32 v51, v51, v67
  v_add_f32 v52, v52, v68
  v_add_f32 v53, v53, v69
  v_add_f32 v54, v54, v70
  v_add_f32 v55, v55, v71
  v_cvt_pk_bf16_f32 v104, v48, v49
  v_cvt_pk_bf16_f32 v105, v50, v51
  v_cvt_pk_bf16_f32 v106, v52, v53
  v_cvt_pk_bf16_f32 v107, v54, v55
  buffer_store_dwordx4 v[104:107], v249, s[20:23], 0 offen
  s_branch K2_DONE
K2_ONE:
  s_waitcnt vmcnt(0) lgkmcnt(0)
  v_lshlrev_b32 v80, 16, v240
  v_and_b32 v81, 0xffff0000, v240
  v_lshlrev_b32 v82, 16, v241
  v_and_b32 v83, 0xffff0000, v241
  v_lshlrev_b32 v84, 16, v242
  v_and_b32 v85, 0xffff0000, v242
  v_lshlrev_b32 v86, 16, v243
  v_and_b32 v87, 0xffff0000, v243
  v_add_f32 v16, v16, v24
  v_add_f32 v32, v32, v40
  v_add_f32 v17, v17, v25
  v_add_f32 v33, v33, v41
  v_add_f32 v18, v18, v26
  v_add_f32 v34, v34, v42
  v_add_f32 v19, v19, v27
  v_add_f32 v35, v35, v43
  v_add_f32 v20, v20, v28
  v_add_f32 v36, v36, v44
  v_add_f32 v21, v21, v29
  v_add_f32 v37, v37, v45
  v_add_f32 v22, v22, v30
  v_add_f32 v38, v38, v46
  v_add_f32 v23, v23, v31
  v_add_f32 v39, v39, v47
  v_add_f32 v16, v16, v80
  v_add_f32 v17, v17, v81
  v_add_f32 v18, v18, v82
  v_add_f32 v19, v19, v83
  v_add_f32 v20, v20, v84
  v_add_f32 v21, v21, v85
  v_add_f32 v22, v22, v86
  v_add_f32 v23, v23, v87
  v_add_f32 v16, v16, v32
  v_add_f32 v17, v17, v33
  v_add_f32 v18, v18, v34
  v_add_f32 v19, v19, v35
  v_add_f32 v20, v20, v36
  v_add_f32 v21, v21, v37
  v_add_f32 v22, v22, v38
  v_add_f32 v23, v23, v39
  v_cvt_pk_bf16_f32 v88, v16, v17
  v_cvt_pk_bf16_f32 v89, v18, v19
  v_cvt_pk_bf16_f32 v90, v20, v21
  v_cvt_pk_bf16_f32 v91, v22, v23
  buffer_store_dwordx4 v[88:91], v248, s[20:23], 0 offen
K2_DONE:
KM_END:
  s_endpgm
KM_CODE_END:
  s_endpgm
.section .rodata,"a"
.p2align 6
.amdhsa_kernel parallel_sum__linear_attn_block__dense_activation_relu__prompt_kernel
  .amdhsa_next_free_vgpr 256
  .amdhsa_next_free_sgpr 102
  .amdhsa_accum_offset 256
  .amdhsa_group_segment_fixed_size 0
  .amdhsa_kernarg_size 72
  .amdhsa_user_sgpr_count 2
  .amdhsa_user_sgpr_kernarg_segment_ptr 1
  .amdhsa_system_sgpr_workgroup_id_x 1
.end_amdhsa_kernel
```
